```python
import torch

def _softmax(x, axis=-1):
    return torch.softmax(x, dim=axis)
def _gelu(x):
    return torch.nn.functional.gelu(x, approximate="tanh")
def _silu(x):
    return torch.nn.functional.silu(x)
def _sigmoid(x):
    return torch.sigmoid(x)
def _layernorm(x, axis=-1, eps=1e-5):
    m = x.mean(dim=axis, keepdim=True)
    v = x.var(dim=axis, keepdim=True, unbiased=False)
    return (x - m) / torch.sqrt(v + eps)
def _scatter_add(tgt, idx, src, axis=0):
    return tgt.clone().index_add_(axis, idx, src)
def _segment_sum(src, seg, n):
    out = torch.zeros((n,) + src.shape[1:], dtype=src.dtype)
    return out.index_add_(0, seg, src)
def _pad(x, pw):
    flat = tuple(v for pair in reversed(pw) for v in pair)
    return torch.nn.functional.pad(x, flat)

kernel_name = 'standalone__kv_cache_quant_int4_int2_kv_with_per_channel_or_per_token_scales__sampling'

def setup_inputs():

    _w = (lambda a: (lambda t: t.to(torch.bfloat16) if t.is_floating_point() else t)(torch.as_tensor(a)))
    B = 8
    Sq = 32
    Skv = 8192
    Hq = 32
    Hkv = 8
    Dh = 128
    bits = 4
    G = 64
    if G <= 0 or G >= Skv:
        G = max(1, Skv // 2)
    Skv = (Skv // G) * G
    ngk = Skv // G
    qmax = (1 << bits) - 1
    return {
        "q": _w((lambda *s: torch.randn(*s, dtype=torch.bfloat16) * 1.6)(B, Hq, Sq, Dh)),
        "qk": _w(torch.randint(0, qmax + 1, (B, Hkv, Skv, Dh)).to(torch.int32)),
        "qv": _w(torch.randint(0, qmax + 1, (B, Hkv, Skv, Dh)).to(torch.int32)),
        "k_scales": _w(torch.abs((lambda *s: torch.randn(*s, dtype=torch.bfloat16) * 1.6)(B, Hkv, ngk, Dh)) * 0.05 + 0.02),
        "k_zeros": _w((lambda *s: torch.randn(*s, dtype=torch.bfloat16) * 1.6)(B, Hkv, ngk, Dh) + float(qmax) / 2.0),
        "v_scales": _w(torch.abs((lambda *s: torch.randn(*s, dtype=torch.bfloat16) * 0.05)(B, Hkv, Skv, 1)) * 0.05 + 0.02),
        "v_zeros": _w((lambda *s: torch.randn(*s, dtype=torch.bfloat16) * 0.05)(B, Hkv, Skv, 1) + float(qmax) / 2.0),
    }

def reference(q, qk, qv, k_scales, k_zeros, v_scales, v_zeros):
    B, Hq, Sq, Dh = q.shape
    Hkv, Skv = qk.shape[1], qk.shape[2]
    ngk = k_scales.shape[2]
    G = Skv // ngk
    ks = (lambda x, n, axis: torch.repeat_interleave(x, n, dim=axis))(k_scales, G, axis=2)
    kz = (lambda x, n, axis: torch.repeat_interleave(x, n, dim=axis))(k_zeros, G, axis=2)
    k = ((lambda x, dt: x.to(dt))(qk, q.dtype) - kz) * ks
    v = ((lambda x, dt: x.to(dt))(qv, q.dtype) - v_zeros) * v_scales
    rep = Hq // Hkv
    if rep > 1:
        k = (lambda x, n, axis: torch.repeat_interleave(x, n, dim=axis))(k, rep, axis=1)
        v = (lambda x, n, axis: torch.repeat_interleave(x, n, dim=axis))(v, rep, axis=1)
    scale = float(Dh) ** -0.5
    logits = torch.einsum("bhqd,bhkd->bhqk", q, k) * scale
    p = _softmax(logits, axis=-1)
    o = torch.einsum("bhqk,bhkd->bhqd", p, v)
    return o
```

```asm
; @launch grid=(256,1,1) block=(256,1,1) lds=144384
.amdgcn_target "amdgcn-amd-amdhsa--gfx950"
.text
.globl standalone__kv_cache_quant_int4_int2_kv_with_per_channel_or_per_token_scales__sampling_kernel
.p2align 8
.type standalone__kv_cache_quant_int4_int2_kv_with_per_channel_or_per_token_scales__sampling_kernel,@function
standalone__kv_cache_quant_int4_int2_kv_with_per_channel_or_per_token_scales__sampling_kernel:
    s_cmp_ge_u32 s2, 256
    s_cbranch_scc1 L_end
    s_load_dwordx16 s[40:55], s[0:1], 0
    s_load_dwordx4 s[56:59], s[0:1], 64
    v_and_b32 v1, 63, v0
    v_lshrrev_b32 v15, 6, v0
    s_nop 0
    v_readfirstlane_b32 s3, v15
    s_and_b32 s68, s2, 7
    s_lshr_b32 s69, s2, 3
    s_and_b32 s61, s69, 3
    s_lshr_b32 s69, s69, 2
    s_lshl_b32 s69, s69, 3
    s_add_u32 s60, s69, s68
    s_mov_b32 s65, 0x3e0293ee
    v_and_b32 v121, 31, v1
    v_lshrrev_b32 v122, 5, v1
    v_lshlrev_b32 v123, 13, v15
    v_lshl_add_u32 v2, v1, 4, v123
    v_lshl_add_u32 v3, v121, 4, v123
    v_lshl_add_u32 v3, v122, 11, v3
    s_lshl_b32 s62, s61, 20
    s_add_u32 s63, s62, 4096
    s_add_u32 s76, s62, 32768
    s_add_u32 s77, s62, 36864
    s_lshl_b32 s69, s60, 22
    s_waitcnt lgkmcnt(0)
    s_add_u32 s4, s42, s69
    s_addc_u32 s5, s43, 0
    s_mov_b32 s6, 4194304
    s_mov_b32 s7, 0x00020000
    s_add_u32 s8, s44, s69
    s_addc_u32 s9, s45, 0
    s_mov_b32 s10, 4194304
    s_mov_b32 s11, 0x00020000
    buffer_load_dwordx4 a[96:99], v2, s[4:7], s62 offen offset:0 nt
    buffer_load_dwordx4 a[100:103], v2, s[4:7], s62 offen offset:1024 nt
    buffer_load_dwordx4 a[104:107], v2, s[4:7], s62 offen offset:2048 nt
    buffer_load_dwordx4 a[108:111], v2, s[4:7], s62 offen offset:3072 nt
    buffer_load_dwordx4 a[112:115], v2, s[4:7], s63 offen offset:0 nt
    buffer_load_dwordx4 a[116:119], v2, s[4:7], s63 offen offset:1024 nt
    buffer_load_dwordx4 a[120:123], v2, s[4:7], s63 offen offset:2048 nt
    buffer_load_dwordx4 a[124:127], v2, s[4:7], s63 offen offset:3072 nt
    buffer_load_dwordx4 a[128:131], v3, s[8:11], s62 offen offset:0 nt
    buffer_load_dwordx4 a[132:135], v3, s[8:11], s62 offen offset:512 nt
    buffer_load_dwordx4 a[136:139], v3, s[8:11], s62 offen offset:1024 nt
    buffer_load_dwordx4 a[140:143], v3, s[8:11], s62 offen offset:1536 nt
    buffer_load_dwordx4 a[144:147], v3, s[8:11], s63 offen offset:0 nt
    buffer_load_dwordx4 a[148:151], v3, s[8:11], s63 offen offset:512 nt
    buffer_load_dwordx4 a[152:155], v3, s[8:11], s63 offen offset:1024 nt
    buffer_load_dwordx4 a[156:159], v3, s[8:11], s63 offen offset:1536 nt
    s_lshl_b32 s69, s60, 15
    s_add_u32 s24, s46, s69
    s_addc_u32 s25, s47, 0
    s_mov_b32 s26, 32768
    s_mov_b32 s27, 0x00020000
    s_add_u32 s28, s48, s69
    s_addc_u32 s29, s49, 0
    s_mov_b32 s30, 32768
    s_mov_b32 s31, 0x00020000
    s_add_u32 s12, s40, s69
    s_addc_u32 s13, s41, 0
    s_mov_b32 s14, 32768
    s_mov_b32 s15, 0x00020000
    s_add_u32 s72, s54, s69
    s_addc_u32 s73, s55, 0
    s_mov_b32 s74, 32768
    s_mov_b32 s75, 0x00020000
    s_lshl_b32 s69, s60, 14
    s_add_u32 s32, s50, s69
    s_addc_u32 s33, s51, 0
    s_mov_b32 s34, 16384
    s_mov_b32 s35, 0x00020000
    s_add_u32 s36, s52, s69
    s_addc_u32 s37, s53, 0
    s_mov_b32 s38, 16384
    s_mov_b32 s39, 0x00020000
    s_lshl_b32 s69, s60, 2
    s_add_u32 s20, s56, s69
    s_addc_u32 s21, s57, 0
    s_mov_b32 s22, 4
    s_mov_b32 s23, 0x00020000
    s_mul_i32 s69, s60, 279168
    s_add_u32 s16, s58, s69
    s_addc_u32 s17, s59, 0
    s_mov_b32 s18, 279168
    s_mov_b32 s19, 0x00020000
    s_lshl_b32 s69, s3, 7
    s_add_u32 s69, s69, 278528
    v_mov_b32 v127, s69
    buffer_load_dwordx4 a[228:231], v127, s[16:19], 0 offen sc0 sc1
    v_mov_b32 v198, 279040
    buffer_load_dwordx2 a[232:233], v198, s[16:19], 0 offen sc0 sc1
    v_lshl_add_u32 v123, v15, 5, v121
    v_lshlrev_b32 v123, 8, v123
    v_lshl_add_u32 v124, v122, 4, v123
    v_lshlrev_b32 v125, 5, v0
    v_lshlrev_b32 v126, 4, v0
    v_lshlrev_b32 v127, 2, v0
    s_lshl_b32 s68, s61, 13
    s_lshl_b32 s69, s61, 12
    buffer_load_dwordx4 v[56:59], v125, s[24:27], s68 offen
    buffer_load_dwordx4 v[60:63], v125, s[24:27], s68 offen offset:16
    buffer_load_dwordx4 v[64:67], v125, s[28:31], s68 offen
    buffer_load_dwordx4 v[68:71], v125, s[28:31], s68 offen offset:16
    buffer_load_dwordx4 v[72:75], v126, s[32:35], s69 offen
    buffer_load_dwordx4 v[76:79], v126, s[36:39], s69 offen
    v_cmp_gt_u32 vcc, 128, v0
    v_mov_b32 v123, 2130706432
    s_nop 0
    v_cndmask_b32 v123, v123, v127, vcc
    s_add_u32 s70, s61, 1
    s_and_b32 s70, s70, 3
    s_lshl_b32 s71, s70, 12
    s_add_u32 s71, s71, 3584
    s_lshl_b32 s70, s70, 13
    s_add_u32 s70, s70, 7168
    buffer_load_dword v212, v127, s[24:27], s70 offen
    buffer_load_dword v213, v127, s[28:31], s70 offen
    buffer_load_dword v214, v123, s[32:35], s71 offen
    buffer_load_dword v215, v123, s[36:39], s71 offen
    s_add_u32 s70, s61, 2
    s_and_b32 s70, s70, 3
    s_lshl_b32 s71, s70, 12
    s_add_u32 s71, s71, 3584
    s_lshl_b32 s70, s70, 13
    s_add_u32 s70, s70, 7168
    buffer_load_dword v216, v127, s[24:27], s70 offen
    buffer_load_dword v217, v127, s[28:31], s70 offen
    buffer_load_dword v218, v123, s[32:35], s71 offen
    buffer_load_dword v219, v123, s[36:39], s71 offen
    s_add_u32 s70, s61, 3
    s_and_b32 s70, s70, 3
    s_lshl_b32 s71, s70, 12
    s_add_u32 s71, s71, 3584
    s_lshl_b32 s70, s70, 13
    s_add_u32 s70, s70, 7168
    buffer_load_dword v220, v127, s[24:27], s70 offen
    buffer_load_dword v221, v127, s[28:31], s70 offen
    buffer_load_dword v222, v123, s[32:35], s71 offen
    buffer_load_dword v223, v123, s[36:39], s71 offen
    buffer_load_dwordx4 a[64:67], v124, s[12:15], 0 offen offset:0
    buffer_load_dwordx4 a[68:71], v124, s[12:15], 0 offen offset:32
    buffer_load_dwordx4 a[72:75], v124, s[12:15], 0 offen offset:64
    buffer_load_dwordx4 a[76:79], v124, s[12:15], 0 offen offset:96
    buffer_load_dwordx4 a[80:83], v124, s[12:15], 0 offen offset:128
    buffer_load_dwordx4 a[84:87], v124, s[12:15], 0 offen offset:160
    buffer_load_dwordx4 a[88:91], v124, s[12:15], 0 offen offset:192
    buffer_load_dwordx4 a[92:95], v124, s[12:15], 0 offen offset:224
    buffer_load_dwordx4 v[128:131], v2, s[4:7], s76 offen offset:0 nt
    buffer_load_dwordx4 v[132:135], v2, s[4:7], s76 offen offset:1024 nt
    buffer_load_dwordx4 v[136:139], v2, s[4:7], s76 offen offset:2048 nt
    buffer_load_dwordx4 v[140:143], v2, s[4:7], s76 offen offset:3072 nt
    buffer_load_dwordx4 v[144:147], v2, s[4:7], s77 offen offset:0 nt
    buffer_load_dwordx4 v[148:151], v2, s[4:7], s77 offen offset:1024 nt
    v_lshl_add_u32 v123, v15, 4, v122
    v_mul_u32_u24 v123, 272, v123
    v_lshl_add_u32 v4, v121, 3, v123
    v_lshlrev_b32 v123, 12, v15
    v_lshl_add_u32 v123, v122, 11, v123
    v_lshl_add_u32 v123, v121, 4, v123
    v_add_u32 v5, 17408, v123
    v_mul_u32_u24 v123, 272, v121
    v_lshl_add_u32 v6, v122, 4, v123
    v_lshlrev_b32 v123, 11, v122
    v_lshl_add_u32 v123, v121, 4, v123
    v_add_u32 v7, 17408, v123
    v_lshlrev_b32 v123, 4, v121
    v_add_u32 v192, 99328, v123
    v_lshlrev_b32 v123, 6, v15
    v_lshl_add_u32 v123, v122, 4, v123
    v_add_u32 v193, 33792, v123
    v_mov_b32 v8, v192
    v_mov_b32 v9, v193
    v_mov_b32 v194, 56320
    v_mov_b32 v195, 0
    v_accvgpr_write_b32 a0, 0
    v_accvgpr_write_b32 a1, 0
    v_accvgpr_write_b32 a2, 0
    v_accvgpr_write_b32 a3, 0
    v_accvgpr_write_b32 a4, 0
    v_accvgpr_write_b32 a5, 0
    v_accvgpr_write_b32 a6, 0
    v_accvgpr_write_b32 a7, 0
    v_accvgpr_write_b32 a8, 0
    v_accvgpr_write_b32 a9, 0
    v_accvgpr_write_b32 a10, 0
    v_accvgpr_write_b32 a11, 0
    v_accvgpr_write_b32 a12, 0
    v_accvgpr_write_b32 a13, 0
    v_accvgpr_write_b32 a14, 0
    v_accvgpr_write_b32 a15, 0
    v_accvgpr_write_b32 a16, 0
    v_accvgpr_write_b32 a17, 0
    v_accvgpr_write_b32 a18, 0
    v_accvgpr_write_b32 a19, 0
    v_accvgpr_write_b32 a20, 0
    v_accvgpr_write_b32 a21, 0
    v_accvgpr_write_b32 a22, 0
    v_accvgpr_write_b32 a23, 0
    v_accvgpr_write_b32 a24, 0
    v_accvgpr_write_b32 a25, 0
    v_accvgpr_write_b32 a26, 0
    v_accvgpr_write_b32 a27, 0
    v_accvgpr_write_b32 a28, 0
    v_accvgpr_write_b32 a29, 0
    v_accvgpr_write_b32 a30, 0
    v_accvgpr_write_b32 a31, 0
    v_accvgpr_write_b32 a32, 0
    v_accvgpr_write_b32 a33, 0
    v_accvgpr_write_b32 a34, 0
    v_accvgpr_write_b32 a35, 0
    v_accvgpr_write_b32 a36, 0
    v_accvgpr_write_b32 a37, 0
    v_accvgpr_write_b32 a38, 0
    v_accvgpr_write_b32 a39, 0
    v_accvgpr_write_b32 a40, 0
    v_accvgpr_write_b32 a41, 0
    v_accvgpr_write_b32 a42, 0
    v_accvgpr_write_b32 a43, 0
    v_accvgpr_write_b32 a44, 0
    v_accvgpr_write_b32 a45, 0
    v_accvgpr_write_b32 a46, 0
    v_accvgpr_write_b32 a47, 0
    v_accvgpr_write_b32 a48, 0
    v_accvgpr_write_b32 a49, 0
    v_accvgpr_write_b32 a50, 0
    v_accvgpr_write_b32 a51, 0
    v_accvgpr_write_b32 a52, 0
    v_accvgpr_write_b32 a53, 0
    v_accvgpr_write_b32 a54, 0
    v_accvgpr_write_b32 a55, 0
    v_accvgpr_write_b32 a56, 0
    v_accvgpr_write_b32 a57, 0
    v_accvgpr_write_b32 a58, 0
    v_accvgpr_write_b32 a59, 0
    v_accvgpr_write_b32 a60, 0
    v_accvgpr_write_b32 a61, 0
    v_accvgpr_write_b32 a62, 0
    v_accvgpr_write_b32 a63, 0
    v_mov_b32 v10, 0xff61b1e6
    v_mov_b32 v12, 0xff61b1e6
    v_mov_b32 v11, 0
    v_mov_b32 v13, 0
    v_mov_b32 v14, 0
    v_lshrrev_b32 v123, 3, v0
    v_and_b32 v121, 7, v0
    v_lshlrev_b32 v125, 10, v123
    v_lshl_add_u32 v125, v121, 6, v125
    v_add_u32 v125, 99328, v125
    v_lshlrev_b32 v126, 9, v123
    v_lshl_add_u32 v126, v121, 5, v126
    v_add_u32 v126, 33792, v126
    v_lshlrev_b32 v124, 10, v15
    v_lshl_add_u32 v124, v1, 3, v124
    v_add_u32 v124, 132096, v124
    v_lshrrev_b32 v123, 5, v0
    v_and_b32 v121, 31, v0
    v_lshlrev_b32 v127, 9, v123
    v_lshl_add_u32 v127, v121, 3, v127
    v_add_u32 v127, 50176, v127
    s_waitcnt vmcnt(26)
    v_accvgpr_read_b32 v80, a228
    v_accvgpr_read_b32 v81, a229
    v_accvgpr_read_b32 v82, a230
    v_accvgpr_read_b32 v83, a231
    v_accvgpr_read_b32 v84, a232
    v_accvgpr_read_b32 v85, a233
    s_nop 0
    v_readfirstlane_b32 s28, v80
    v_readfirstlane_b32 s29, v81
    v_readfirstlane_b32 s30, v82
    v_readfirstlane_b32 s31, v83
    v_readfirstlane_b32 s100, v84
    v_readfirstlane_b32 s101, v85
    s_getpc_b64 s[24:25]
L_pc:
    s_add_u32 s24, s24, L_rescale-L_pc
    s_addc_u32 s25, s25, 0
    v_lshlrev_b32 v80, 16, v56
    v_and_b32 v81, 0xffff0000, v56
    v_lshlrev_b32 v96, 16, v64
    v_and_b32 v97, 0xffff0000, v64
    v_lshlrev_b32 v82, 16, v57
    v_and_b32 v83, 0xffff0000, v57
    v_lshlrev_b32 v98, 16, v65
    v_and_b32 v99, 0xffff0000, v65
    v_lshlrev_b32 v84, 16, v58
    v_and_b32 v85, 0xffff0000, v58
    v_lshlrev_b32 v100, 16, v66
    v_and_b32 v101, 0xffff0000, v66
    v_lshlrev_b32 v86, 16, v59
    v_and_b32 v87, 0xffff0000, v59
    v_lshlrev_b32 v102, 16, v67
    v_and_b32 v103, 0xffff0000, v67
    v_lshlrev_b32 v88, 16, v60
    v_and_b32 v89, 0xffff0000, v60
    v_lshlrev_b32 v104, 16, v68
    v_and_b32 v105, 0xffff0000, v68
    v_lshlrev_b32 v90, 16, v61
    v_and_b32 v91, 0xffff0000, v61
    v_lshlrev_b32 v106, 16, v69
    v_and_b32 v107, 0xffff0000, v69
    v_lshlrev_b32 v92, 16, v62
    v_and_b32 v93, 0xffff0000, v62
    v_lshlrev_b32 v108, 16, v70
    v_and_b32 v109, 0xffff0000, v70
    v_lshlrev_b32 v94, 16, v63
    v_and_b32 v95, 0xffff0000, v63
    v_lshlrev_b32 v110, 16, v71
    v_and_b32 v111, 0xffff0000, v71
    v_mul_f32 v96, -v96, v80
    v_mul_f32 v97, -v97, v81
    v_mul_f32 v98, -v98, v82
    v_mul_f32 v99, -v99, v83
    v_mul_f32 v100, -v100, v84
    v_mul_f32 v101, -v101, v85
    v_mul_f32 v102, -v102, v86
    v_mul_f32 v103, -v103, v87
    v_mul_f32 v104, -v104, v88
    v_mul_f32 v105, -v105, v89
    v_mul_f32 v106, -v106, v90
    v_mul_f32 v107, -v107, v91
    v_mul_f32 v108, -v108, v92
    v_mul_f32 v109, -v109, v93
    v_mul_f32 v110, -v110, v94
    v_mul_f32 v111, -v111, v95
    ds_write_b128 v125, v[80:83] offset:0
    ds_write_b128 v125, v[96:99] offset:512
    ds_write_b128 v125, v[84:87] offset:16
    ds_write_b128 v125, v[100:103] offset:528
    ds_write_b128 v125, v[88:91] offset:32
    ds_write_b128 v125, v[104:107] offset:544
    ds_write_b128 v125, v[92:95] offset:48
    ds_write_b128 v125, v[108:111] offset:560
    v_lshlrev_b32 v112, 16, v72
    v_and_b32 v113, 0xffff0000, v72
    v_lshlrev_b32 v114, 16, v73
    v_and_b32 v115, 0xffff0000, v73
    v_lshlrev_b32 v116, 16, v74
    v_and_b32 v117, 0xffff0000, v74
    v_lshlrev_b32 v118, 16, v75
    v_and_b32 v119, 0xffff0000, v75
    v_lshlrev_b32 v64, 16, v76
    v_and_b32 v65, 0xffff0000, v76
    v_lshlrev_b32 v66, 16, v77
    v_and_b32 v67, 0xffff0000, v77
    v_lshlrev_b32 v68, 16, v78
    v_and_b32 v69, 0xffff0000, v78
    v_lshlrev_b32 v70, 16, v79
    v_and_b32 v71, 0xffff0000, v79
    v_mul_f32 v64, -v64, v112
    v_mul_f32 v65, -v65, v113
    v_mul_f32 v66, -v66, v114
    v_mul_f32 v67, -v67, v115
    v_mul_f32 v68, -v68, v116
    v_mul_f32 v69, -v69, v117
    v_mul_f32 v70, -v70, v118
    v_mul_f32 v71, -v71, v119
    ds_write_b128 v126, v[112:115] offset:0
    ds_write_b128 v126, v[116:119] offset:16
    ds_write_b128 v126, v[64:67] offset:256
    ds_write_b128 v126, v[68:71] offset:272
    s_waitcnt vmcnt(24)
    v_lshlrev_b32 v40, 16, v212
    v_and_b32 v41, 0xffff0000, v212
    v_lshlrev_b32 v42, 16, v213
    v_and_b32 v43, 0xffff0000, v213
    v_mul_f32 v42, -v42, v40
    v_mul_f32 v43, -v43, v41
    s_waitcnt vmcnt(22)
    v_lshlrev_b32 v44, 16, v214
    v_and_b32 v45, 0xffff0000, v214
    v_lshlrev_b32 v46, 16, v215
    v_and_b32 v47, 0xffff0000, v215
    v_mul_f32 v46, -v46, v44
    v_mul_f32 v47, -v47, v45
    ds_write_b64 v124, v[40:41] offset:0
    ds_write_b64 v124, v[42:43] offset:512
    s_waitcnt vmcnt(20)
    v_lshlrev_b32 v48, 16, v216
    v_and_b32 v49, 0xffff0000, v216
    v_lshlrev_b32 v50, 16, v217
    v_and_b32 v51, 0xffff0000, v217
    v_mul_f32 v50, -v50, v48
    v_mul_f32 v51, -v51, v49
    s_waitcnt vmcnt(18)
    v_lshlrev_b32 v52, 16, v218
    v_and_b32 v53, 0xffff0000, v218
    v_lshlrev_b32 v54, 16, v219
    v_and_b32 v55, 0xffff0000, v219
    v_mul_f32 v54, -v54, v52
    v_mul_f32 v55, -v55, v53
    ds_write_b64 v124, v[48:49] offset:4096
    ds_write_b64 v124, v[50:51] offset:4608
    s_waitcnt vmcnt(16)
    v_lshlrev_b32 v56, 16, v220
    v_and_b32 v57, 0xffff0000, v220
    v_lshlrev_b32 v58, 16, v221
    v_and_b32 v59, 0xffff0000, v221
    v_mul_f32 v58, -v58, v56
    v_mul_f32 v59, -v59, v57
    s_waitcnt vmcnt(14)
    v_lshlrev_b32 v60, 16, v222
    v_and_b32 v61, 0xffff0000, v222
    v_lshlrev_b32 v62, 16, v223
    v_and_b32 v63, 0xffff0000, v223
    v_mul_f32 v62, -v62, v60
    v_mul_f32 v63, -v63, v61
    ds_write_b64 v124, v[56:57] offset:8192
    ds_write_b64 v124, v[58:59] offset:8704
    s_cmp_ge_u32 s3, 2
    s_cbranch_scc1 L_novpool
    ds_write_b64 v127, v[44:45] offset:0
    ds_write_b64 v127, v[46:47] offset:256
    ds_write_b64 v127, v[52:53] offset:2048
    ds_write_b64 v127, v[54:55] offset:2304
    ds_write_b64 v127, v[60:61] offset:4096
    ds_write_b64 v127, v[62:63] offset:4352
L_novpool:
    s_waitcnt lgkmcnt(0)
    s_barrier
    s_mov_b32 s37, 0
    s_mov_b32 s39, 0
    s_mov_b32 s64, 1
    s_cmp_lg_u32 s3, 0
    s_cbranch_scc1 L_noticket
    s_mov_b32 s57, 1
    v_mov_b32 v204, s57
    s_nop 1
    v_accvgpr_write_b32 a224, v204
    s_lshl_b32 s69, s61, 5
    s_add_u32 s69, s69, 514
    v_mov_b32 v204, s69
    s_mov_b64 exec, 1
    buffer_atomic_add a224, v195, s[20:23], 0 offen sc0 sc1
    ds_write_b32 v194, v204
    s_mov_b64 exec, -1
L_noticket:
    ds_read_b128 v[16:19], v8 offset:0
    ds_read_b128 v[20:23], v8 offset:512
    ds_read_b128 v[24:27], v9 offset:0
    ds_read_b128 v[28:31], v9 offset:32
    ds_read_b128 v[32:35], v9 offset:256
    ds_read_b128 v[36:39], v9 offset:288
    v_accvgpr_read_b32 v121, a96
    v_accvgpr_read_b32 v122, a97
    v_accvgpr_read_b32 v123, a98
    v_accvgpr_read_b32 v124, a99
    v_cvt_f32_i32 v121, v121
    v_cvt_f32_i32 v122, v122
    v_cvt_f32_i32 v123, v123
    v_cvt_f32_i32 v124, v124
    s_waitcnt lgkmcnt(4)
    v_fma_f32 v121, v121, v16, v20
    v_fma_f32 v122, v122, v17, v21
    v_fma_f32 v123, v123, v18, v22
    v_fma_f32 v124, v124, v19, v23
    v_cvt_pk_bf16_f32 v40, v121, v122
    v_cvt_pk_bf16_f32 v41, v123, v124
    ds_write_b64 v4, v[40:41] offset:0
    v_accvgpr_read_b32 v125, a100
    v_accvgpr_read_b32 v126, a101
    v_accvgpr_read_b32 v127, a102
    v_accvgpr_read_b32 v0, a103
    v_cvt_f32_i32 v125, v125
    v_cvt_f32_i32 v126, v126
    v_cvt_f32_i32 v127, v127
    v_cvt_f32_i32 v0, v0
    v_fma_f32 v125, v125, v16, v20
    v_fma_f32 v126, v126, v17, v21
    v_fma_f32 v127, v127, v18, v22
    v_fma_f32 v0, v0, v19, v23
    v_cvt_pk_bf16_f32 v42, v125, v126
    v_cvt_pk_bf16_f32 v43, v127, v0
    ds_write_b64 v4, v[42:43] offset:544
    v_accvgpr_read_b32 v121, a104
    v_accvgpr_read_b32 v122, a105
    v_accvgpr_read_b32 v123, a106
    v_accvgpr_read_b32 v124, a107
    v_cvt_f32_i32 v121, v121
    v_cvt_f32_i32 v122, v122
    v_cvt_f32_i32 v123, v123
    v_cvt_f32_i32 v124, v124
    v_fma_f32 v121, v121, v16, v20
    v_fma_f32 v122, v122, v17, v21
    v_fma_f32 v123, v123, v18, v22
    v_fma_f32 v124, v124, v19, v23
    v_cvt_pk_bf16_f32 v44, v121, v122
    v_cvt_pk_bf16_f32 v45, v123, v124
    ds_write_b64 v4, v[44:45] offset:1088
    v_accvgpr_read_b32 v125, a108
    v_accvgpr_read_b32 v126, a109
    v_accvgpr_read_b32 v127, a110
    v_accvgpr_read_b32 v0, a111
    v_cvt_f32_i32 v125, v125
    v_cvt_f32_i32 v126, v126
    v_cvt_f32_i32 v127, v127
    v_cvt_f32_i32 v0, v0
    v_fma_f32 v125, v125, v16, v20
    v_fma_f32 v126, v126, v17, v21
    v_fma_f32 v127, v127, v18, v22
    v_fma_f32 v0, v0, v19, v23
    v_cvt_pk_bf16_f32 v46, v125, v126
    v_cvt_pk_bf16_f32 v47, v127, v0
    ds_write_b64 v4, v[46:47] offset:1632
    v_accvgpr_read_b32 v121, a112
    v_accvgpr_read_b32 v122, a113
    v_accvgpr_read_b32 v123, a114
    v_accvgpr_read_b32 v124, a115
    v_cvt_f32_i32 v121, v121
    v_cvt_f32_i32 v122, v122
    v_cvt_f32_i32 v123, v123
    v_cvt_f32_i32 v124, v124
    v_fma_f32 v121, v121, v16, v20
    v_fma_f32 v122, v122, v17, v21
    v_fma_f32 v123, v123, v18, v22
    v_fma_f32 v124, v124, v19, v23
    v_cvt_pk_bf16_f32 v48, v121, v122
    v_cvt_pk_bf16_f32 v49, v123, v124
    ds_write_b64 v4, v[48:49] offset:2176
    v_accvgpr_read_b32 v125, a116
    v_accvgpr_read_b32 v126, a117
    v_accvgpr_read_b32 v127, a118
    v_accvgpr_read_b32 v0, a119
    v_cvt_f32_i32 v125, v125
    v_cvt_f32_i32 v126, v126
    v_cvt_f32_i32 v127, v127
    v_cvt_f32_i32 v0, v0
    v_fma_f32 v125, v125, v16, v20
    v_fma_f32 v126, v126, v17, v21
    v_fma_f32 v127, v127, v18, v22
    v_fma_f32 v0, v0, v19, v23
    v_cvt_pk_bf16_f32 v50, v125, v126
    v_cvt_pk_bf16_f32 v51, v127, v0
    ds_write_b64 v4, v[50:51] offset:2720
    v_accvgpr_read_b32 v121, a120
    v_accvgpr_read_b32 v122, a121
    v_accvgpr_read_b32 v123, a122
    v_accvgpr_read_b32 v124, a123
    v_cvt_f32_i32 v121, v121
    v_cvt_f32_i32 v122, v122
    v_cvt_f32_i32 v123, v123
    v_cvt_f32_i32 v124, v124
    v_fma_f32 v121, v121, v16, v20
    v_fma_f32 v122, v122, v17, v21
    v_fma_f32 v123, v123, v18, v22
    v_fma_f32 v124, v124, v19, v23
    v_cvt_pk_bf16_f32 v52, v121, v122
    v_cvt_pk_bf16_f32 v53, v123, v124
    ds_write_b64 v4, v[52:53] offset:3264
    v_accvgpr_read_b32 v125, a124
    v_accvgpr_read_b32 v126, a125
    v_accvgpr_read_b32 v127, a126
    v_accvgpr_read_b32 v0, a127
    v_cvt_f32_i32 v125, v125
    v_cvt_f32_i32 v126, v126
    v_cvt_f32_i32 v127, v127
    v_cvt_f32_i32 v0, v0
    v_fma_f32 v125, v125, v16, v20
    v_fma_f32 v126, v126, v17, v21
    v_fma_f32 v127, v127, v18, v22
    v_fma_f32 v0, v0, v19, v23
    v_cvt_pk_bf16_f32 v54, v125, v126
    v_cvt_pk_bf16_f32 v55, v127, v0
    ds_write_b64 v4, v[54:55] offset:3808
    v_accvgpr_read_b32 v121, a128
    v_accvgpr_read_b32 v122, a129
    v_accvgpr_read_b32 v123, a130
    v_accvgpr_read_b32 v124, a131
    v_cvt_f32_i32 v121, v121
    v_cvt_f32_i32 v122, v122
    v_cvt_f32_i32 v123, v123
    v_cvt_f32_i32 v124, v124
    s_waitcnt lgkmcnt(9)
    v_fma_f32 v121, v121, v24, v32
    v_fma_f32 v122, v122, v24, v32
    v_fma_f32 v123, v123, v24, v32
    v_fma_f32 v124, v124, v24, v32
    v_accvgpr_read_b32 v125, a132
    v_accvgpr_read_b32 v126, a133
    v_accvgpr_read_b32 v127, a134
    v_accvgpr_read_b32 v0, a135
    v_cvt_f32_i32 v125, v125
    v_cvt_f32_i32 v126, v126
    v_cvt_f32_i32 v127, v127
    v_cvt_f32_i32 v0, v0
    v_fma_f32 v125, v125, v25, v33
    v_fma_f32 v126, v126, v25, v33
    v_fma_f32 v127, v127, v25, v33
    v_fma_f32 v0, v0, v25, v33
    v_cvt_pk_bf16_f32 v104, v121, v125
    v_cvt_pk_bf16_f32 v108, v122, v126
    v_cvt_pk_bf16_f32 v112, v123, v127
    v_cvt_pk_bf16_f32 v116, v124, v0
    v_accvgpr_read_b32 v121, a136
    v_accvgpr_read_b32 v122, a137
    v_accvgpr_read_b32 v123, a138
    v_accvgpr_read_b32 v124, a139
    v_cvt_f32_i32 v121, v121
    v_cvt_f32_i32 v122, v122
    v_cvt_f32_i32 v123, v123
    v_cvt_f32_i32 v124, v124
    v_fma_f32 v121, v121, v26, v34
    v_fma_f32 v122, v122, v26, v34
    v_fma_f32 v123, v123, v26, v34
    v_fma_f32 v124, v124, v26, v34
    v_accvgpr_read_b32 v125, a140
    v_accvgpr_read_b32 v126, a141
    v_accvgpr_read_b32 v127, a142
    v_accvgpr_read_b32 v0, a143
    v_cvt_f32_i32 v125, v125
    v_cvt_f32_i32 v126, v126
    v_cvt_f32_i32 v127, v127
    v_cvt_f32_i32 v0, v0
    v_fma_f32 v125, v125, v27, v35
    v_fma_f32 v126, v126, v27, v35
    v_fma_f32 v127, v127, v27, v35
    v_fma_f32 v0, v0, v27, v35
    v_cvt_pk_bf16_f32 v105, v121, v125
    v_cvt_pk_bf16_f32 v109, v122, v126
    v_cvt_pk_bf16_f32 v113, v123, v127
    v_cvt_pk_bf16_f32 v117, v124, v0
    v_accvgpr_read_b32 v121, a144
    v_accvgpr_read_b32 v122, a145
    v_accvgpr_read_b32 v123, a146
    v_accvgpr_read_b32 v124, a147
    v_cvt_f32_i32 v121, v121
    v_cvt_f32_i32 v122, v122
    v_cvt_f32_i32 v123, v123
    v_cvt_f32_i32 v124, v124
    s_waitcnt lgkmcnt(8)
    v_fma_f32 v121, v121, v28, v36
    v_fma_f32 v122, v122, v28, v36
    v_fma_f32 v123, v123, v28, v36
    v_fma_f32 v124, v124, v28, v36
    v_accvgpr_read_b32 v125, a148
    v_accvgpr_read_b32 v126, a149
    v_accvgpr_read_b32 v127, a150
    v_accvgpr_read_b32 v0, a151
    v_cvt_f32_i32 v125, v125
    v_cvt_f32_i32 v126, v126
    v_cvt_f32_i32 v127, v127
    v_cvt_f32_i32 v0, v0
    v_fma_f32 v125, v125, v29, v37
    v_fma_f32 v126, v126, v29, v37
    v_fma_f32 v127, v127, v29, v37
    v_fma_f32 v0, v0, v29, v37
    v_cvt_pk_bf16_f32 v106, v121, v125
    v_cvt_pk_bf16_f32 v110, v122, v126
    v_cvt_pk_bf16_f32 v114, v123, v127
    v_cvt_pk_bf16_f32 v118, v124, v0
    v_accvgpr_read_b32 v121, a152
    v_accvgpr_read_b32 v122, a153
    v_accvgpr_read_b32 v123, a154
    v_accvgpr_read_b32 v124, a155
    v_cvt_f32_i32 v121, v121
    v_cvt_f32_i32 v122, v122
    v_cvt_f32_i32 v123, v123
    v_cvt_f32_i32 v124, v124
    v_fma_f32 v121, v121, v30, v38
    v_fma_f32 v122, v122, v30, v38
    v_fma_f32 v123, v123, v30, v38
    v_fma_f32 v124, v124, v30, v38
    v_accvgpr_read_b32 v125, a156
    v_accvgpr_read_b32 v126, a157
    v_accvgpr_read_b32 v127, a158
    v_accvgpr_read_b32 v0, a159
    v_cvt_f32_i32 v125, v125
    v_cvt_f32_i32 v126, v126
    v_cvt_f32_i32 v127, v127
    v_cvt_f32_i32 v0, v0
    v_fma_f32 v125, v125, v31, v39
    v_fma_f32 v126, v126, v31, v39
    v_fma_f32 v127, v127, v31, v39
    v_fma_f32 v0, v0, v31, v39
    v_cvt_pk_bf16_f32 v107, v121, v125
    v_cvt_pk_bf16_f32 v111, v122, v126
    v_cvt_pk_bf16_f32 v115, v123, v127
    v_cvt_pk_bf16_f32 v119, v124, v0
    ds_write_b128 v5, v[104:107] offset:0
    ds_write_b128 v5, v[108:111] offset:512
    ds_write_b128 v5, v[112:115] offset:1024
    ds_write_b128 v5, v[116:119] offset:1536
    s_mov_b32 s62, s76
    s_mov_b32 s63, s77
    v_add_u32 v8, 1024, v192
    v_add_u32 v9, 512, v193
    v_xor_b32 v4, 65536, v4
    s_waitcnt vmcnt(6)
    v_xor_b32 v5, 65536, v5
    s_waitcnt lgkmcnt(0)
    s_barrier
L_loop:
    ds_read_b128 v[200:203], v194
    ds_read_b128 v[16:19], v8 offset:0
    ds_read_b128 v[20:23], v8 offset:512
    ds_read_b128 v[24:27], v9 offset:0
    ds_read_b128 v[28:31], v9 offset:32
    ds_read_b128 v[32:35], v9 offset:256
    ds_read_b128 v[36:39], v9 offset:288
    ds_read_b128 a[96:99], v6 offset:0
    ds_read_b128 a[100:103], v6 offset:32
    ds_read_b128 a[104:107], v6 offset:64
    ds_read_b128 a[108:111], v6 offset:96
    ds_read_b128 a[112:115], v6 offset:128
    ds_read_b128 a[116:119], v6 offset:160
    ds_read_b128 a[120:123], v6 offset:192
    ds_read_b128 a[124:127], v6 offset:224
    ds_read_b128 a[128:131], v6 offset:8704
    ds_read_b128 a[132:135], v6 offset:8736
    ds_read_b128 a[136:139], v6 offset:8768
    ds_read_b128 a[140:143], v6 offset:8800
    ds_read_b128 a[144:147], v6 offset:8832
    ds_read_b128 a[148:151], v6 offset:8864
    ds_read_b128 a[152:155], v6 offset:8896
    ds_read_b128 a[156:159], v6 offset:8928
    s_cmp_lg_u32 s3, 0
    s_cbranch_scc1 L_noclaim_l
    s_cmp_lt_u32 s64, 25
    s_cbranch_scc1 L_noclaim_l
    s_cmp_eq_u32 s64, 25
    s_cbranch_scc0 L_claim2_l
    buffer_load_dwordx2 v[196:197], v198, s[16:19], 0 offen sc0 sc1
    s_branch L_noclaim_l
L_claim2_l:
    s_cmp_eq_u32 s37, 0
    s_cbranch_scc1 L_noclaim_l
    v_mov_b32 v196, 1
    s_mov_b64 exec, 1
    buffer_atomic_add v196, v198, s[16:19], 0 offen sc0 sc1
    s_mov_b64 exec, -1
L_noclaim_l:
    s_waitcnt vmcnt(5)
    buffer_load_dwordx4 v[152:155], v2, s[4:7], s63 offen offset:2048 nt
    v_cvt_f32_i32 v121, v128
    v_cvt_f32_i32 v122, v129
    v_cvt_f32_i32 v123, v130
    v_cvt_f32_i32 v124, v131
    s_waitcnt lgkmcnt(15)
    v_fma_f32 v121, v121, v16, v20
    v_fma_f32 v122, v122, v17, v21
    v_fma_f32 v123, v123, v18, v22
    v_fma_f32 v124, v124, v19, v23
    v_cvt_pk_bf16_f32 v40, v121, v122
    v_cvt_pk_bf16_f32 v41, v123, v124
    ds_write_b64 v4, v[40:41] offset:0
    s_waitcnt vmcnt(5)
    buffer_load_dwordx4 v[156:159], v2, s[4:7], s63 offen offset:3072 nt
    v_cvt_f32_i32 v125, v132
    v_cvt_f32_i32 v126, v133
    v_cvt_f32_i32 v127, v134
    v_cvt_f32_i32 v0, v135
    v_fma_f32 v125, v125, v16, v20
    v_fma_f32 v126, v126, v17, v21
    v_fma_f32 v127, v127, v18, v22
    v_fma_f32 v0, v0, v19, v23
    v_cvt_pk_bf16_f32 v42, v125, v126
    v_cvt_pk_bf16_f32 v43, v127, v0
    ds_write_b64 v4, v[42:43] offset:544
    v_mfma_f32_32x32x16_bf16 v[56:71], a[96:99], a[64:67], 0
    ds_read_b128 a[160:163], v7 offset:0
    ds_read_b128 a[164:167], v7 offset:512
    s_waitcnt vmcnt(5)
    buffer_load_dwordx4 v[160:163], v3, s[8:11], s62 offen offset:0 nt
    v_cvt_f32_i32 v121, v136
    v_cvt_f32_i32 v122, v137
    v_cvt_f32_i32 v123, v138
    v_cvt_f32_i32 v124, v139
    v_fma_f32 v121, v121, v16, v20
    s_waitcnt lgkmcnt(15)
    v_mfma_f32_32x32x16_bf16 v[56:71], a[100:103], a[68:71], v[56:71]
    v_fma_f32 v122, v122, v17, v21
    v_fma_f32 v123, v123, v18, v22
    v_fma_f32 v124, v124, v19, v23
    v_cvt_pk_bf16_f32 v44, v121, v122
    v_cvt_pk_bf16_f32 v45, v123, v124
    ds_write_b64 v4, v[44:45] offset:1088
    ds_read_b128 a[168:171], v7 offset:1024
    ds_read_b128 a[172:175], v7 offset:1536
    v_mfma_f32_32x32x16_bf16 v[56:71], a[104:107], a[72:75], v[56:71]
    s_waitcnt vmcnt(5)
    buffer_load_dwordx4 v[164:167], v3, s[8:11], s62 offen offset:512 nt
    v_cvt_f32_i32 v125, v140
    v_cvt_f32_i32 v126, v141
    v_cvt_f32_i32 v127, v142
    v_cvt_f32_i32 v0, v143
    v_fma_f32 v125, v125, v16, v20
    v_fma_f32 v126, v126, v17, v21
    v_fma_f32 v127, v127, v18, v22
    v_mfma_f32_32x32x16_bf16 v[56:71], a[108:111], a[76:79], v[56:71]
    v_fma_f32 v0, v0, v19, v23
    v_cvt_pk_bf16_f32 v46, v125, v126
    v_cvt_pk_bf16_f32 v47, v127, v0
    ds_write_b64 v4, v[46:47] offset:1632
    v_readfirstlane_b32 s38, v200
    s_nop 3
    s_and_b32 s68, s38, 255
    s_lshl_b32 s69, s68, 15
    v_mfma_f32_32x32x16_bf16 v[56:71], a[112:115], a[80:83], v[56:71]
    s_cmp_eq_u32 s68, 255
    s_cselect_b32 s76, 2130706432, s69
    s_add_u32 s77, s76, 4096
    ds_read_b128 a[176:179], v7 offset:4096
    ds_read_b128 a[180:183], v7 offset:4608
    s_waitcnt vmcnt(5)
    buffer_load_dwordx4 v[168:171], v3, s[8:11], s62 offen offset:1024 nt
    v_cvt_f32_i32 v121, v144
    v_cvt_f32_i32 v122, v145
    s_waitcnt lgkmcnt(15)
    v_mfma_f32_32x32x16_bf16 v[56:71], a[116:119], a[84:87], v[56:71]
    v_cvt_f32_i32 v123, v146
    v_cvt_f32_i32 v124, v147
    v_fma_f32 v121, v121, v16, v20
    v_fma_f32 v122, v122, v17, v21
    v_fma_f32 v123, v123, v18, v22
    v_fma_f32 v124, v124, v19, v23
    v_cvt_pk_bf16_f32 v48, v121, v122
    v_cvt_pk_bf16_f32 v49, v123, v124
    v_mfma_f32_32x32x16_bf16 v[56:71], a[120:123], a[88:91], v[56:71]
    ds_write_b64 v4, v[48:49] offset:2176
    ds_read_b128 a[184:187], v7 offset:5120
    ds_read_b128 a[188:191], v7 offset:5632
    s_waitcnt vmcnt(5)
    buffer_load_dwordx4 v[172:175], v3, s[8:11], s62 offen offset:1536 nt
    v_cvt_f32_i32 v125, v148
    v_cvt_f32_i32 v126, v149
    v_cvt_f32_i32 v127, v150
    v_cvt_f32_i32 v0, v151
    v_mfma_f32_32x32x16_bf16 v[56:71], a[124:127], a[92:95], v[56:71]
    v_fma_f32 v125, v125, v16, v20
    v_fma_f32 v126, v126, v17, v21
    v_fma_f32 v127, v127, v18, v22
    v_fma_f32 v0, v0, v19, v23
    v_cvt_pk_bf16_f32 v50, v125, v126
    v_cvt_pk_bf16_f32 v51, v127, v0
    ds_write_b64 v4, v[50:51] offset:2720
    ds_read_b128 a[192:195], v7 offset:8192
    v_mfma_f32_32x32x16_bf16 v[72:87], a[128:131], a[64:67], 0
    ds_read_b128 a[196:199], v7 offset:8704
    s_waitcnt vmcnt(5)
    buffer_load_dwordx4 v[176:179], v3, s[8:11], s63 offen offset:0 nt
    v_cvt_f32_i32 v121, v152
    v_cvt_f32_i32 v122, v153
    v_cvt_f32_i32 v123, v154
    v_cvt_f32_i32 v124, v155
    v_fma_f32 v121, v121, v16, v20
    v_fma_f32 v122, v122, v17, v21
    v_mfma_f32_32x32x16_bf16 v[72:87], a[132:135], a[68:71], v[72:87]
    v_fma_f32 v123, v123, v18, v22
    v_fma_f32 v124, v124, v19, v23
    v_cvt_pk_bf16_f32 v52, v121, v122
    v_cvt_pk_bf16_f32 v53, v123, v124
    ds_write_b64 v4, v[52:53] offset:3264
    ds_read_b128 a[200:203], v7 offset:9216
    ds_read_b128 a[204:207], v7 offset:9728
    s_waitcnt vmcnt(5)
    buffer_load_dwordx4 v[180:183], v3, s[8:11], s63 offen offset:512 nt
    v_mfma_f32_32x32x16_bf16 v[72:87], a[136:139], a[72:75], v[72:87]
    v_cvt_f32_i32 v125, v156
    v_cvt_f32_i32 v126, v157
    v_cvt_f32_i32 v127, v158
    v_cvt_f32_i32 v0, v159
    v_fma_f32 v125, v125, v16, v20
    v_fma_f32 v126, v126, v17, v21
    v_fma_f32 v127, v127, v18, v22
    v_fma_f32 v0, v0, v19, v23
    s_waitcnt lgkmcnt(15)
    v_mfma_f32_32x32x16_bf16 v[72:87], a[140:143], a[76:79], v[72:87]
    v_cvt_pk_bf16_f32 v54, v125, v126
    v_cvt_pk_bf16_f32 v55, v127, v0
    ds_write_b64 v4, v[54:55] offset:3808
    ds_read_b128 a[208:211], v7 offset:12288
    ds_read_b128 a[212:215], v7 offset:12800
    s_waitcnt vmcnt(5)
    buffer_load_dwordx4 v[184:187], v3, s[8:11], s63 offen offset:1024 nt
    v_cvt_f32_i32 v121, v160
    v_cvt_f32_i32 v122, v161
    v_mfma_f32_32x32x16_bf16 v[72:87], a[144:147], a[80:83], v[72:87]
    v_cvt_f32_i32 v123, v162
    v_cvt_f32_i32 v124, v163
    v_fma_f32 v121, v121, v24, v32
    v_fma_f32 v122, v122, v24, v32
    v_fma_f32 v123, v123, v24, v32
    v_fma_f32 v124, v124, v24, v32
    ds_read_b128 a[216:219], v7 offset:13312
    ds_read_b128 a[220:223], v7 offset:13824
    v_mfma_f32_32x32x16_bf16 v[72:87], a[148:151], a[84:87], v[72:87]
    s_waitcnt vmcnt(5)
    buffer_load_dwordx4 v[188:191], v3, s[8:11], s63 offen offset:1536 nt
    v_cvt_f32_i32 v125, v164
    v_cvt_f32_i32 v126, v165
    v_cvt_f32_i32 v127, v166
    v_cvt_f32_i32 v0, v167
    v_fma_f32 v125, v125, v25, v33
    v_fma_f32 v126, v126, v25, v33
    v_fma_f32 v127, v127, v25, v33
    v_mfma_f32_32x32x16_bf16 v[72:87], a[152:155], a[88:91], v[72:87]
    v_fma_f32 v0, v0, v25, v33
    v_cvt_pk_bf16_f32 v104, v121, v125
    v_cvt_pk_bf16_f32 v108, v122, v126
    v_cvt_pk_bf16_f32 v112, v123, v127
    v_cvt_pk_bf16_f32 v116, v124, v0
    v_mfma_f32_32x32x16_bf16 v[72:87], a[156:159], a[92:95], v[72:87]
    v_max3_f32 v15, v56, v57, v58
    v_max3_f32 v15, v15, v59, v60
    v_max3_f32 v15, v15, v61, v62
    v_max3_f32 v15, v15, v63, v64
    v_max3_f32 v15, v15, v65, v66
    v_max3_f32 v15, v15, v67, v68
    v_max3_f32 v15, v15, v69, v70
    s_nop 4
    v_max3_f32 v15, v15, v71, v72
    v_max3_f32 v15, v15, v73, v74
    v_max3_f32 v15, v15, v75, v76
    v_max3_f32 v15, v15, v77, v78
    v_max3_f32 v15, v15, v79, v80
    v_max3_f32 v15, v15, v81, v82
    v_max3_f32 v15, v15, v83, v84
    v_max3_f32 v15, v15, v85, v86
    v_max_f32 v15, v15, v87
    v_mov_b32 v120, v15
    s_nop 1
    v_permlane32_swap_b32 v15, v120
    v_max_f32 v15, v15, v120
    v_cmp_gt_f32 vcc, v15, v12
    s_cbranch_vccnz L_resc_l
L_back_l:
    v_fma_f32 v56, v56, s65, v11
    v_fma_f32 v57, v57, s65, v11
    v_fma_f32 v58, v58, s65, v11
    v_fma_f32 v59, v59, s65, v11
    v_fma_f32 v60, v60, s65, v11
    v_fma_f32 v61, v61, s65, v11
    v_fma_f32 v62, v62, s65, v11
    v_fma_f32 v63, v63, s65, v11
    v_exp_f32 v56, v56
    v_exp_f32 v57, v57
    v_exp_f32 v58, v58
    v_exp_f32 v59, v59
    v_exp_f32 v60, v60
    v_exp_f32 v61, v61
    v_exp_f32 v62, v62
    v_exp_f32 v63, v63
    v_cvt_pk_bf16_f32 v88, v56, v57
    v_cvt_pk_bf16_f32 v89, v58, v59
    v_cvt_pk_bf16_f32 v90, v60, v61
    v_cvt_pk_bf16_f32 v91, v62, v63
    v_add_f32 v13, v13, v56
    v_add_f32 v14, v14, v57
    v_add_f32 v13, v13, v58
    v_add_f32 v14, v14, v59
    v_add_f32 v13, v13, v60
    v_add_f32 v14, v14, v61
    v_add_f32 v13, v13, v62
    v_add_f32 v14, v14, v63
    v_fma_f32 v64, v64, s65, v11
    v_fma_f32 v65, v65, s65, v11
    v_fma_f32 v66, v66, s65, v11
    v_fma_f32 v67, v67, s65, v11
    v_fma_f32 v68, v68, s65, v11
    v_fma_f32 v69, v69, s65, v11
    v_fma_f32 v70, v70, s65, v11
    v_fma_f32 v71, v71, s65, v11
    v_exp_f32 v64, v64
    v_exp_f32 v65, v65
    v_exp_f32 v66, v66
    v_exp_f32 v67, v67
    v_exp_f32 v68, v68
    v_exp_f32 v69, v69
    v_exp_f32 v70, v70
    v_exp_f32 v71, v71
    v_cvt_pk_bf16_f32 v92, v64, v65
    v_cvt_pk_bf16_f32 v93, v66, v67
    v_cvt_pk_bf16_f32 v94, v68, v69
    v_cvt_pk_bf16_f32 v95, v70, v71
    v_add_f32 v13, v13, v64
    v_add_f32 v14, v14, v65
    v_add_f32 v13, v13, v66
    v_add_f32 v14, v14, v67
    v_add_f32 v13, v13, v68
    v_add_f32 v14, v14, v69
    v_add_f32 v13, v13, v70
    v_add_f32 v14, v14, v71
    v_fma_f32 v72, v72, s65, v11
    v_fma_f32 v73, v73, s65, v11
    v_mfma_f32_32x32x16_bf16 a[0:15], a[160:163], v[88:91], a[0:15]
    v_fma_f32 v74, v74, s65, v11
    v_fma_f32 v75, v75, s65, v11
    v_fma_f32 v76, v76, s65, v11
    v_fma_f32 v77, v77, s65, v11
    v_fma_f32 v78, v78, s65, v11
    v_fma_f32 v79, v79, s65, v11
    v_exp_f32 v72, v72
    v_mfma_f32_32x32x16_bf16 a[16:31], a[164:167], v[88:91], a[16:31]
    v_exp_f32 v73, v73
    v_exp_f32 v74, v74
    v_exp_f32 v75, v75
    v_exp_f32 v76, v76
    v_exp_f32 v77, v77
    v_exp_f32 v78, v78
    v_exp_f32 v79, v79
    s_waitcnt lgkmcnt(15)
    v_mfma_f32_32x32x16_bf16 a[32:47], a[168:171], v[88:91], a[32:47]
    v_cvt_pk_bf16_f32 v96, v72, v73
    v_cvt_pk_bf16_f32 v97, v74, v75
    v_cvt_pk_bf16_f32 v98, v76, v77
    v_cvt_pk_bf16_f32 v99, v78, v79
    v_add_f32 v13, v13, v72
    v_add_f32 v14, v14, v73
    v_add_f32 v13, v13, v74
    v_mfma_f32_32x32x16_bf16 a[48:63], a[172:175], v[88:91], a[48:63]
    v_add_f32 v14, v14, v75
    v_add_f32 v13, v13, v76
    v_add_f32 v14, v14, v77
    v_add_f32 v13, v13, v78
    v_add_f32 v14, v14, v79
    v_fma_f32 v80, v80, s65, v11
    v_fma_f32 v81, v81, s65, v11
    v_mfma_f32_32x32x16_bf16 a[0:15], a[176:179], v[92:95], a[0:15]
    v_fma_f32 v82, v82, s65, v11
    v_fma_f32 v83, v83, s65, v11
    v_fma_f32 v84, v84, s65, v11
    v_fma_f32 v85, v85, s65, v11
    v_fma_f32 v86, v86, s65, v11
    v_fma_f32 v87, v87, s65, v11
    v_exp_f32 v80, v80
    s_waitcnt lgkmcnt(14)
    v_mfma_f32_32x32x16_bf16 a[16:31], a[180:183], v[92:95], a[16:31]
    v_exp_f32 v81, v81
    v_exp_f32 v82, v82
    v_exp_f32 v83, v83
    v_exp_f32 v84, v84
    v_exp_f32 v85, v85
    v_exp_f32 v86, v86
    v_exp_f32 v87, v87
    s_waitcnt lgkmcnt(12)
    v_mfma_f32_32x32x16_bf16 a[32:47], a[184:187], v[92:95], a[32:47]
    v_cvt_pk_bf16_f32 v100, v80, v81
    v_cvt_pk_bf16_f32 v101, v82, v83
    v_cvt_pk_bf16_f32 v102, v84, v85
    v_cvt_pk_bf16_f32 v103, v86, v87
    v_add_f32 v13, v13, v80
    v_add_f32 v14, v14, v81
    v_add_f32 v13, v13, v82
    s_waitcnt lgkmcnt(11)
    v_mfma_f32_32x32x16_bf16 a[48:63], a[188:191], v[92:95], a[48:63]
    v_add_f32 v14, v14, v83
    v_add_f32 v13, v13, v84
    v_add_f32 v14, v14, v85
    v_add_f32 v13, v13, v86
    v_add_f32 v14, v14, v87
    s_waitcnt vmcnt(5)
    buffer_load_dwordx4 v[128:131], v2, s[4:7], s76 offen offset:0 nt
    v_cvt_f32_i32 v121, v168
    s_waitcnt lgkmcnt(9)
    v_mfma_f32_32x32x16_bf16 a[0:15], a[192:195], v[96:99], a[0:15]
    v_cvt_f32_i32 v122, v169
    v_cvt_f32_i32 v123, v170
    v_cvt_f32_i32 v124, v171
    v_fma_f32 v121, v121, v26, v34
    v_fma_f32 v122, v122, v26, v34
    v_fma_f32 v123, v123, v26, v34
    v_fma_f32 v124, v124, v26, v34
    s_waitcnt vmcnt(5)
    buffer_load_dwordx4 v[132:135], v2, s[4:7], s76 offen offset:1024 nt
    v_cvt_f32_i32 v125, v172
    s_waitcnt lgkmcnt(8)
    v_mfma_f32_32x32x16_bf16 a[16:31], a[196:199], v[96:99], a[16:31]
    v_cvt_f32_i32 v126, v173
    v_cvt_f32_i32 v127, v174
    v_cvt_f32_i32 v0, v175
    v_fma_f32 v125, v125, v27, v35
    v_fma_f32 v126, v126, v27, v35
    v_fma_f32 v127, v127, v27, v35
    v_fma_f32 v0, v0, v27, v35
    v_cvt_pk_bf16_f32 v105, v121, v125
    v_cvt_pk_bf16_f32 v109, v122, v126
    s_waitcnt lgkmcnt(6)
    v_mfma_f32_32x32x16_bf16 a[32:47], a[200:203], v[96:99], a[32:47]
    v_cvt_pk_bf16_f32 v113, v123, v127
    v_cvt_pk_bf16_f32 v117, v124, v0
    s_waitcnt vmcnt(5)
    buffer_load_dwordx4 v[136:139], v2, s[4:7], s76 offen offset:2048 nt
    v_cvt_f32_i32 v121, v176
    v_cvt_f32_i32 v122, v177
    v_cvt_f32_i32 v123, v178
    v_cvt_f32_i32 v124, v179
    v_fma_f32 v121, v121, v28, v36
    v_fma_f32 v122, v122, v28, v36
    s_waitcnt lgkmcnt(5)
    v_mfma_f32_32x32x16_bf16 a[48:63], a[204:207], v[96:99], a[48:63]
    v_fma_f32 v123, v123, v28, v36
    v_fma_f32 v124, v124, v28, v36
    s_waitcnt vmcnt(5)
    buffer_load_dwordx4 v[140:143], v2, s[4:7], s76 offen offset:3072 nt
    v_cvt_f32_i32 v125, v180
    v_cvt_f32_i32 v126, v181
    v_cvt_f32_i32 v127, v182
    v_cvt_f32_i32 v0, v183
    v_fma_f32 v125, v125, v29, v37
    v_fma_f32 v126, v126, v29, v37
    s_waitcnt lgkmcnt(3)
    v_mfma_f32_32x32x16_bf16 a[0:15], a[208:211], v[100:103], a[0:15]
    v_fma_f32 v127, v127, v29, v37
    v_fma_f32 v0, v0, v29, v37
    v_cvt_pk_bf16_f32 v106, v121, v125
    v_cvt_pk_bf16_f32 v110, v122, v126
    v_cvt_pk_bf16_f32 v114, v123, v127
    v_cvt_pk_bf16_f32 v118, v124, v0
    s_waitcnt vmcnt(5)
    buffer_load_dwordx4 v[144:147], v2, s[4:7], s77 offen offset:0 nt
    v_cvt_f32_i32 v121, v184
    v_cvt_f32_i32 v122, v185
    s_waitcnt lgkmcnt(2)
    v_mfma_f32_32x32x16_bf16 a[16:31], a[212:215], v[100:103], a[16:31]
    v_cvt_f32_i32 v123, v186
    v_cvt_f32_i32 v124, v187
    v_fma_f32 v121, v121, v30, v38
    v_fma_f32 v122, v122, v30, v38
    v_fma_f32 v123, v123, v30, v38
    v_fma_f32 v124, v124, v30, v38
    s_waitcnt vmcnt(5)
    buffer_load_dwordx4 v[148:151], v2, s[4:7], s77 offen offset:1024 nt
    v_cvt_f32_i32 v125, v188
    v_cvt_f32_i32 v126, v189
    s_waitcnt lgkmcnt(1)
    v_mfma_f32_32x32x16_bf16 a[32:47], a[216:219], v[100:103], a[32:47]
    v_cvt_f32_i32 v127, v190
    v_cvt_f32_i32 v0, v191
    v_fma_f32 v125, v125, v31, v39
    v_fma_f32 v126, v126, v31, v39
    v_fma_f32 v127, v127, v31, v39
    v_fma_f32 v0, v0, v31, v39
    v_cvt_pk_bf16_f32 v107, v121, v125
    v_cvt_pk_bf16_f32 v111, v122, v126
    v_cvt_pk_bf16_f32 v115, v123, v127
    s_waitcnt lgkmcnt(0)
    v_mfma_f32_32x32x16_bf16 a[48:63], a[220:223], v[100:103], a[48:63]
    v_cvt_pk_bf16_f32 v119, v124, v0
    ds_write_b128 v5, v[104:107] offset:0
    ds_write_b128 v5, v[108:111] offset:512
    ds_write_b128 v5, v[112:115] offset:1024
    ds_write_b128 v5, v[116:119] offset:1536
    s_cmp_lg_u32 s3, 0
    s_cbranch_scc1 L_nosched_l
    v_accvgpr_read_b32 v205, a224
    s_cmp_lg_u32 s64, 1
    s_cbranch_scc1 L_nogo_l
    v_readfirstlane_b32 s68, v205
    s_nop 3
    s_and_b32 s69, s68, 7
    s_cmp_lg_u32 s69, 3
    s_cbranch_scc1 L_nogo_l
    s_mov_b32 s69, 1
    s_add_u32 s68, s101, s69
    v_mov_b32 v204, s68
    s_mov_b64 exec, 1
    buffer_store_dword v204, v198, s[16:19], 0 offen offset:4 sc0 sc1
    s_mov_b64 exec, -1
    s_lshl_b32 s39, s69, 3
    s_and_b32 s39, s39, 16
    s_or_b32 s39, s39, 4
L_nogo_l:
    s_cmp_lg_u32 s64, 25
    s_cbranch_scc1 L_nogo2_l
    v_readfirstlane_b32 s68, v197
    s_nop 3
    s_sub_u32 s68, s68, s101
    s_cmp_eq_u32 s68, 1
    s_cselect_b32 s39, 4, s39
    s_cmp_eq_u32 s68, 2
    s_cselect_b32 s39, 20, s39
    s_bfe_u32 s37, s39, 65538
L_nogo2_l:
    s_add_u32 s68, s64, 2
    s_lshl_b32 s69, s61, 5
    s_add_u32 s69, s69, s68
    s_lshl_b32 s70, s68, 8
    s_or_b32 s69, s69, s70
    s_cmp_lt_u32 s64, 26
    s_cbranch_scc1 L_schedw_l
    s_mov_b32 s69, 255
    s_cmp_eq_u32 s37, 0
    s_cbranch_scc1 L_schedw_l
    v_readfirstlane_b32 s68, v196
    s_nop 3
    s_sub_u32 s68, s68, s100
    s_cmp_lt_u32 s68, 16
    s_cselect_b32 s37, 1, 0
    s_cbranch_scc0 L_schedw_l
    s_and_b32 s70, s68, 3
    s_lshr_b32 s68, s68, 2
    s_lshl_b32 s69, s70, 5
    s_add_u32 s69, s69, s68
    s_add_u32 s69, s69, 28
    s_sub_u32 s70, s70, s61
    s_and_b32 s70, s70, 3
    s_mul_i32 s70, s70, 4
    s_add_u32 s70, s70, s68
    s_add_u32 s70, s70, 28
    s_lshl_b32 s70, s70, 8
    s_or_b32 s69, s69, s70
L_schedw_l:
    v_mov_b32 v204, s69
    v_mov_b32 v206, s39
    v_xor_b32 v207, 16, v194
    s_mov_b64 exec, 1
    ds_write_b96 v207, v[204:206]
    s_mov_b64 exec, -1
L_nosched_l:
    s_mov_b32 s62, s76
    s_mov_b32 s63, s77
    s_lshr_b32 s68, s38, 8
    s_lshl_b32 s69, s68, 10
    s_lshl_b32 s68, s68, 9
    v_add_u32 v8, s69, v192
    v_add_u32 v9, s68, v193
    v_xor_b32 v6, 65536, v6
    v_xor_b32 v7, 65536, v7
    v_xor_b32 v4, 65536, v4
    v_xor_b32 v5, 65536, v5
    v_xor_b32 v194, 16, v194
    s_add_u32 s64, s64, 1
    s_cmp_ge_u32 s64, 48
    s_cselect_b32 s68, 2130706432, s62
    s_cmp_eq_u32 s68, 2130706432
    s_waitcnt lgkmcnt(0)
    s_barrier
    s_cbranch_scc0 L_loop
L_last:
    ds_read_b128 a[96:99], v6 offset:0
    ds_read_b128 a[100:103], v6 offset:32
    ds_read_b128 a[104:107], v6 offset:64
    ds_read_b128 a[108:111], v6 offset:96
    ds_read_b128 a[112:115], v6 offset:128
    ds_read_b128 a[116:119], v6 offset:160
    ds_read_b128 a[120:123], v6 offset:192
    ds_read_b128 a[124:127], v6 offset:224
    ds_read_b128 a[128:131], v6 offset:8704
    ds_read_b128 a[132:135], v6 offset:8736
    ds_read_b128 a[136:139], v6 offset:8768
    ds_read_b128 a[140:143], v6 offset:8800
    ds_read_b128 a[144:147], v6 offset:8832
    ds_read_b128 a[148:151], v6 offset:8864
    ds_read_b128 a[152:155], v6 offset:8896
    ds_read_b128 a[156:159], v6 offset:8928
    s_waitcnt lgkmcnt(15)
    v_mfma_f32_32x32x16_bf16 v[56:71], a[96:99], a[64:67], 0
    ds_read_b128 a[160:163], v7 offset:0
    s_waitcnt lgkmcnt(15)
    v_mfma_f32_32x32x16_bf16 v[56:71], a[100:103], a[68:71], v[56:71]
    ds_read_b128 a[164:167], v7 offset:512
    s_waitcnt lgkmcnt(15)
    v_mfma_f32_32x32x16_bf16 v[56:71], a[104:107], a[72:75], v[56:71]
    ds_read_b128 a[168:171], v7 offset:1024
    s_waitcnt lgkmcnt(15)
    v_mfma_f32_32x32x16_bf16 v[56:71], a[108:111], a[76:79], v[56:71]
    ds_read_b128 a[172:175], v7 offset:1536
    s_waitcnt lgkmcnt(15)
    v_mfma_f32_32x32x16_bf16 v[56:71], a[112:115], a[80:83], v[56:71]
    ds_read_b128 a[176:179], v7 offset:4096
    s_waitcnt lgkmcnt(15)
    v_mfma_f32_32x32x16_bf16 v[56:71], a[116:119], a[84:87], v[56:71]
    ds_read_b128 a[180:183], v7 offset:4608
    s_waitcnt lgkmcnt(15)
    v_mfma_f32_32x32x16_bf16 v[56:71], a[120:123], a[88:91], v[56:71]
    ds_read_b128 a[184:187], v7 offset:5120
    s_waitcnt lgkmcnt(15)
    v_mfma_f32_32x32x16_bf16 v[56:71], a[124:127], a[92:95], v[56:71]
    ds_read_b128 a[188:191], v7 offset:5632
    s_waitcnt lgkmcnt(15)
    v_mfma_f32_32x32x16_bf16 v[72:87], a[128:131], a[64:67], 0
    ds_read_b128 a[192:195], v7 offset:8192
    s_waitcnt lgkmcnt(15)
    v_mfma_f32_32x32x16_bf16 v[72:87], a[132:135], a[68:71], v[72:87]
    ds_read_b128 a[196:199], v7 offset:8704
    s_waitcnt lgkmcnt(15)
    v_mfma_f32_32x32x16_bf16 v[72:87], a[136:139], a[72:75], v[72:87]
    ds_read_b128 a[200:203], v7 offset:9216
    s_waitcnt lgkmcnt(15)
    v_mfma_f32_32x32x16_bf16 v[72:87], a[140:143], a[76:79], v[72:87]
    ds_read_b128 a[204:207], v7 offset:9728
    s_waitcnt lgkmcnt(15)
    v_mfma_f32_32x32x16_bf16 v[72:87], a[144:147], a[80:83], v[72:87]
    ds_read_b128 a[208:211], v7 offset:12288
    s_waitcnt lgkmcnt(15)
    v_mfma_f32_32x32x16_bf16 v[72:87], a[148:151], a[84:87], v[72:87]
    ds_read_b128 a[212:215], v7 offset:12800
    s_waitcnt lgkmcnt(15)
    v_mfma_f32_32x32x16_bf16 v[72:87], a[152:155], a[88:91], v[72:87]
    ds_read_b128 a[216:219], v7 offset:13312
    s_waitcnt lgkmcnt(15)
    v_mfma_f32_32x32x16_bf16 v[72:87], a[156:159], a[92:95], v[72:87]
    ds_read_b128 a[220:223], v7 offset:13824
    v_max3_f32 v15, v56, v57, v58
    v_max3_f32 v15, v15, v59, v60
    v_max3_f32 v15, v15, v61, v62
    v_max3_f32 v15, v15, v63, v64
    v_max3_f32 v15, v15, v65, v66
    v_max3_f32 v15, v15, v67, v68
    v_max3_f32 v15, v15, v69, v70
    s_nop 3
    v_max3_f32 v15, v15, v71, v72
    v_max3_f32 v15, v15, v73, v74
    v_max3_f32 v15, v15, v75, v76
    v_max3_f32 v15, v15, v77, v78
    v_max3_f32 v15, v15, v79, v80
    v_max3_f32 v15, v15, v81, v82
    v_max3_f32 v15, v15, v83, v84
    v_max3_f32 v15, v15, v85, v86
    v_max_f32 v15, v15, v87
    v_mov_b32 v120, v15
    s_nop 1
    v_permlane32_swap_b32 v15, v120
    v_max_f32 v15, v15, v120
    v_cmp_gt_f32 vcc, v15, v12
    s_cbranch_vccnz L_resc_z
L_back_z:
    v_fma_f32 v56, v56, s65, v11
    v_fma_f32 v57, v57, s65, v11
    v_fma_f32 v58, v58, s65, v11
    v_fma_f32 v59, v59, s65, v11
    v_fma_f32 v60, v60, s65, v11
    v_fma_f32 v61, v61, s65, v11
    v_fma_f32 v62, v62, s65, v11
    v_fma_f32 v63, v63, s65, v11
    v_exp_f32 v56, v56
    v_exp_f32 v57, v57
    v_exp_f32 v58, v58
    v_exp_f32 v59, v59
    v_exp_f32 v60, v60
    v_exp_f32 v61, v61
    v_exp_f32 v62, v62
    v_exp_f32 v63, v63
    v_cvt_pk_bf16_f32 v88, v56, v57
    v_cvt_pk_bf16_f32 v89, v58, v59
    v_cvt_pk_bf16_f32 v90, v60, v61
    v_cvt_pk_bf16_f32 v91, v62, v63
    v_add_f32 v13, v13, v56
    v_add_f32 v14, v14, v57
    v_add_f32 v13, v13, v58
    v_add_f32 v14, v14, v59
    v_add_f32 v13, v13, v60
    v_add_f32 v14, v14, v61
    v_add_f32 v13, v13, v62
    v_add_f32 v14, v14, v63
    v_fma_f32 v64, v64, s65, v11
    v_fma_f32 v65, v65, s65, v11
    v_fma_f32 v66, v66, s65, v11
    v_fma_f32 v67, v67, s65, v11
    v_fma_f32 v68, v68, s65, v11
    v_fma_f32 v69, v69, s65, v11
    v_fma_f32 v70, v70, s65, v11
    v_fma_f32 v71, v71, s65, v11
    v_exp_f32 v64, v64
    v_exp_f32 v65, v65
    v_exp_f32 v66, v66
    v_exp_f32 v67, v67
    v_exp_f32 v68, v68
    v_exp_f32 v69, v69
    v_exp_f32 v70, v70
    v_exp_f32 v71, v71
    v_cvt_pk_bf16_f32 v92, v64, v65
    v_cvt_pk_bf16_f32 v93, v66, v67
    v_cvt_pk_bf16_f32 v94, v68, v69
    v_cvt_pk_bf16_f32 v95, v70, v71
    v_add_f32 v13, v13, v64
    v_add_f32 v14, v14, v65
    v_add_f32 v13, v13, v66
    v_add_f32 v14, v14, v67
    v_add_f32 v13, v13, v68
    v_add_f32 v14, v14, v69
    v_add_f32 v13, v13, v70
    v_add_f32 v14, v14, v71
    v_fma_f32 v72, v72, s65, v11
    v_fma_f32 v73, v73, s65, v11
    s_waitcnt lgkmcnt(15)
    v_mfma_f32_32x32x16_bf16 a[0:15], a[160:163], v[88:91], a[0:15]
    v_fma_f32 v74, v74, s65, v11
    v_fma_f32 v75, v75, s65, v11
    v_fma_f32 v76, v76, s65, v11
    v_fma_f32 v77, v77, s65, v11
    v_fma_f32 v78, v78, s65, v11
    v_fma_f32 v79, v79, s65, v11
    v_exp_f32 v72, v72
    s_waitcnt lgkmcnt(14)
    v_mfma_f32_32x32x16_bf16 a[16:31], a[164:167], v[88:91], a[16:31]
    v_exp_f32 v73, v73
    v_exp_f32 v74, v74
    v_exp_f32 v75, v75
    v_exp_f32 v76, v76
    v_exp_f32 v77, v77
    v_exp_f32 v78, v78
    v_exp_f32 v79, v79
    s_waitcnt lgkmcnt(13)
    v_mfma_f32_32x32x16_bf16 a[32:47], a[168:171], v[88:91], a[32:47]
    v_cvt_pk_bf16_f32 v96, v72, v73
    v_cvt_pk_bf16_f32 v97, v74, v75
    v_cvt_pk_bf16_f32 v98, v76, v77
    v_cvt_pk_bf16_f32 v99, v78, v79
    v_add_f32 v13, v13, v72
    v_add_f32 v14, v14, v73
    v_add_f32 v13, v13, v74
    s_waitcnt lgkmcnt(12)
    v_mfma_f32_32x32x16_bf16 a[48:63], a[172:175], v[88:91], a[48:63]
    v_add_f32 v14, v14, v75
    v_add_f32 v13, v13, v76
    v_add_f32 v14, v14, v77
    v_add_f32 v13, v13, v78
    v_add_f32 v14, v14, v79
    v_fma_f32 v80, v80, s65, v11
    v_fma_f32 v81, v81, s65, v11
    s_waitcnt lgkmcnt(11)
    v_mfma_f32_32x32x16_bf16 a[0:15], a[176:179], v[92:95], a[0:15]
    v_fma_f32 v82, v82, s65, v11
    v_fma_f32 v83, v83, s65, v11
    v_fma_f32 v84, v84, s65, v11
    v_fma_f32 v85, v85, s65, v11
    v_fma_f32 v86, v86, s65, v11
    v_fma_f32 v87, v87, s65, v11
    v_exp_f32 v80, v80
    s_waitcnt lgkmcnt(10)
    v_mfma_f32_32x32x16_bf16 a[16:31], a[180:183], v[92:95], a[16:31]
    v_exp_f32 v81, v81
    v_exp_f32 v82, v82
    v_exp_f32 v83, v83
    v_exp_f32 v84, v84
    v_exp_f32 v85, v85
    v_exp_f32 v86, v86
    v_exp_f32 v87, v87
    s_waitcnt lgkmcnt(9)
    v_mfma_f32_32x32x16_bf16 a[32:47], a[184:187], v[92:95], a[32:47]
    v_cvt_pk_bf16_f32 v100, v80, v81
    v_cvt_pk_bf16_f32 v101, v82, v83
    v_cvt_pk_bf16_f32 v102, v84, v85
    v_cvt_pk_bf16_f32 v103, v86, v87
    v_add_f32 v13, v13, v80
    v_add_f32 v14, v14, v81
    v_add_f32 v13, v13, v82
    s_waitcnt lgkmcnt(8)
    v_mfma_f32_32x32x16_bf16 a[48:63], a[188:191], v[92:95], a[48:63]
    v_add_f32 v14, v14, v83
    v_add_f32 v13, v13, v84
    v_add_f32 v14, v14, v85
    v_add_f32 v13, v13, v86
    v_add_f32 v14, v14, v87
    s_waitcnt lgkmcnt(7)
    v_mfma_f32_32x32x16_bf16 a[0:15], a[192:195], v[96:99], a[0:15]
    s_waitcnt lgkmcnt(6)
    v_mfma_f32_32x32x16_bf16 a[16:31], a[196:199], v[96:99], a[16:31]
    s_waitcnt lgkmcnt(5)
    v_mfma_f32_32x32x16_bf16 a[32:47], a[200:203], v[96:99], a[32:47]
    s_waitcnt lgkmcnt(4)
    v_mfma_f32_32x32x16_bf16 a[48:63], a[204:207], v[96:99], a[48:63]
    s_waitcnt lgkmcnt(3)
    v_mfma_f32_32x32x16_bf16 a[0:15], a[208:211], v[100:103], a[0:15]
    s_waitcnt lgkmcnt(2)
    v_mfma_f32_32x32x16_bf16 a[16:31], a[212:215], v[100:103], a[16:31]
    s_waitcnt lgkmcnt(1)
    v_mfma_f32_32x32x16_bf16 a[32:47], a[216:219], v[100:103], a[32:47]
    s_waitcnt lgkmcnt(0)
    v_mfma_f32_32x32x16_bf16 a[48:63], a[220:223], v[100:103], a[48:63]
    s_waitcnt vmcnt(0)
    v_add_f32 v13, v13, v14
    v_mov_b32 v14, v13
    s_nop 1
    v_permlane32_swap_b32 v13, v14
    v_add_f32 v33, v13, v14
    v_mov_b32 v32, v10
    s_lshl_b32 s68, s3, 7
    s_add_u32 s68, s68, 278528
    v_mov_b32 v143, s68
    buffer_load_dwordx4 v[148:151], v143, s[16:19], 0 offen sc1
    s_lshl_b32 s68, s3, 14
    v_lshlrev_b32 v141, 4, v1
    v_add_u32 v140, s68, v141
    s_lshl_b32 s68, s3, 10
    s_add_u32 s68, s68, 65536
    v_and_b32 v142, 31, v1
    v_lshlrev_b32 v141, 3, v142
    v_add_u32 v141, s68, v141
    v_lshrrev_b32 v15, 5, v1
    v_lshlrev_b32 v142, 8, v142
    v_lshl_add_u32 v142, v15, 5, v142
    s_lshl_b32 s68, s3, 13
    v_add_u32 v142, s68, v142
    v_readfirstlane_b32 s32, v201
    v_readfirstlane_b32 s33, v202
    s_nop 3
    s_and_b32 s66, s33, 7
    s_cmp_lg_u32 s66, 4
    s_cselect_b32 s66, 1, 0
    s_lshr_b32 s34, s32, 3
    s_and_b32 s34, s34, 15
    s_and_b32 s68, s32, 7
    s_cmp_eq_u32 s68, 3
    s_cselect_b32 s35, s34, 0
    s_lshl_b32 s68, 1, s61
    s_or_b32 s34, s34, s68
    s_mul_i32 s71, s61, 69632
    s_add_u32 s68, s71, 4096
    s_add_u32 s69, s71, 8192
    s_add_u32 s70, s71, 12288
    s_lshl_b32 s36, s61, 2
    s_and_b32 s33, s33, 16
    s_cmp_lg_u32 s66, 0
    s_cselect_b32 s33, 0, s33
    s_cmp_eq_u32 s61, 1
    s_cbranch_scc1 L_pub1g
    s_cmp_eq_u32 s61, 2
    s_cbranch_scc1 L_pub2g
    s_cmp_eq_u32 s61, 3
    s_cbranch_scc1 L_pub3g
L_pub0g:
    v_accvgpr_read_b32 v196, a4
    v_accvgpr_read_b32 v197, a5
    v_accvgpr_read_b32 v198, a6
    v_accvgpr_read_b32 v199, a7
    v_cvt_pk_bf16_f32 v160, v196, v197
    v_cvt_pk_bf16_f32 v161, v198, v199
    v_accvgpr_read_b32 v196, a20
    v_accvgpr_read_b32 v197, a21
    v_accvgpr_read_b32 v198, a22
    v_accvgpr_read_b32 v199, a23
    v_cvt_pk_bf16_f32 v162, v196, v197
    v_cvt_pk_bf16_f32 v163, v198, v199
    v_accvgpr_read_b32 v196, a36
    v_accvgpr_read_b32 v197, a37
    v_accvgpr_read_b32 v198, a38
    v_accvgpr_read_b32 v199, a39
    v_cvt_pk_bf16_f32 v164, v196, v197
    v_cvt_pk_bf16_f32 v165, v198, v199
    v_accvgpr_read_b32 v196, a52
    v_accvgpr_read_b32 v197, a53
    v_accvgpr_read_b32 v198, a54
    v_accvgpr_read_b32 v199, a55
    v_cvt_pk_bf16_f32 v166, v196, v197
    v_cvt_pk_bf16_f32 v167, v198, v199
    buffer_store_dwordx4 v[160:163], v140, s[16:19], s68 offen offset:0 sc0 sc1
    buffer_store_dwordx4 v[164:167], v140, s[16:19], s68 offen offset:1024 sc0 sc1
    v_accvgpr_read_b32 v196, a8
    v_accvgpr_read_b32 v197, a9
    v_accvgpr_read_b32 v198, a10
    v_accvgpr_read_b32 v199, a11
    v_cvt_pk_bf16_f32 v168, v196, v197
    v_cvt_pk_bf16_f32 v169, v198, v199
    v_accvgpr_read_b32 v196, a24
    v_accvgpr_read_b32 v197, a25
    v_accvgpr_read_b32 v198, a26
    v_accvgpr_read_b32 v199, a27
    v_cvt_pk_bf16_f32 v170, v196, v197
    v_cvt_pk_bf16_f32 v171, v198, v199
    v_accvgpr_read_b32 v196, a40
    v_accvgpr_read_b32 v197, a41
    v_accvgpr_read_b32 v198, a42
    v_accvgpr_read_b32 v199, a43
    v_cvt_pk_bf16_f32 v172, v196, v197
    v_cvt_pk_bf16_f32 v173, v198, v199
    v_accvgpr_read_b32 v196, a56
    v_accvgpr_read_b32 v197, a57
    v_accvgpr_read_b32 v198, a58
    v_accvgpr_read_b32 v199, a59
    v_cvt_pk_bf16_f32 v174, v196, v197
    v_cvt_pk_bf16_f32 v175, v198, v199
    buffer_store_dwordx4 v[168:171], v140, s[16:19], s69 offen offset:0 sc0 sc1
    buffer_store_dwordx4 v[172:175], v140, s[16:19], s69 offen offset:1024 sc0 sc1
    v_accvgpr_read_b32 v196, a12
    v_accvgpr_read_b32 v197, a13
    v_accvgpr_read_b32 v198, a14
    v_accvgpr_read_b32 v199, a15
    v_cvt_pk_bf16_f32 v176, v196, v197
    v_cvt_pk_bf16_f32 v177, v198, v199
    v_accvgpr_read_b32 v196, a28
    v_accvgpr_read_b32 v197, a29
    v_accvgpr_read_b32 v198, a30
    v_accvgpr_read_b32 v199, a31
    v_cvt_pk_bf16_f32 v178, v196, v197
    v_cvt_pk_bf16_f32 v179, v198, v199
    v_accvgpr_read_b32 v196, a44
    v_accvgpr_read_b32 v197, a45
    v_accvgpr_read_b32 v198, a46
    v_accvgpr_read_b32 v199, a47
    v_cvt_pk_bf16_f32 v180, v196, v197
    v_cvt_pk_bf16_f32 v181, v198, v199
    v_accvgpr_read_b32 v196, a60
    v_accvgpr_read_b32 v197, a61
    v_accvgpr_read_b32 v198, a62
    v_accvgpr_read_b32 v199, a63
    v_cvt_pk_bf16_f32 v182, v196, v197
    v_cvt_pk_bf16_f32 v183, v198, v199
    buffer_store_dwordx4 v[176:179], v140, s[16:19], s70 offen offset:0 sc0 sc1
    buffer_store_dwordx4 v[180:183], v140, s[16:19], s70 offen offset:1024 sc0 sc1
    v_accvgpr_read_b32 v16, a0
    v_accvgpr_read_b32 v17, a1
    v_accvgpr_read_b32 v18, a2
    v_accvgpr_read_b32 v19, a3
    v_accvgpr_read_b32 v20, a16
    v_accvgpr_read_b32 v21, a17
    v_accvgpr_read_b32 v22, a18
    v_accvgpr_read_b32 v23, a19
    v_accvgpr_read_b32 v24, a32
    v_accvgpr_read_b32 v25, a33
    v_accvgpr_read_b32 v26, a34
    v_accvgpr_read_b32 v27, a35
    v_accvgpr_read_b32 v28, a48
    v_accvgpr_read_b32 v29, a49
    v_accvgpr_read_b32 v30, a50
    v_accvgpr_read_b32 v31, a51
    s_mov_b32 s78, s71
    s_add_u32 s67, s28, 1
    s_branch L_pubdoneg
L_pub1g:
    v_accvgpr_read_b32 v196, a0
    v_accvgpr_read_b32 v197, a1
    v_accvgpr_read_b32 v198, a2
    v_accvgpr_read_b32 v199, a3
    v_cvt_pk_bf16_f32 v160, v196, v197
    v_cvt_pk_bf16_f32 v161, v198, v199
    v_accvgpr_read_b32 v196, a16
    v_accvgpr_read_b32 v197, a17
    v_accvgpr_read_b32 v198, a18
    v_accvgpr_read_b32 v199, a19
    v_cvt_pk_bf16_f32 v162, v196, v197
    v_cvt_pk_bf16_f32 v163, v198, v199
    v_accvgpr_read_b32 v196, a32
    v_accvgpr_read_b32 v197, a33
    v_accvgpr_read_b32 v198, a34
    v_accvgpr_read_b32 v199, a35
    v_cvt_pk_bf16_f32 v164, v196, v197
    v_cvt_pk_bf16_f32 v165, v198, v199
    v_accvgpr_read_b32 v196, a48
    v_accvgpr_read_b32 v197, a49
    v_accvgpr_read_b32 v198, a50
    v_accvgpr_read_b32 v199, a51
    v_cvt_pk_bf16_f32 v166, v196, v197
    v_cvt_pk_bf16_f32 v167, v198, v199
    buffer_store_dwordx4 v[160:163], v140, s[16:19], s71 offen offset:0 sc0 sc1
    buffer_store_dwordx4 v[164:167], v140, s[16:19], s71 offen offset:1024 sc0 sc1
    v_accvgpr_read_b32 v196, a8
    v_accvgpr_read_b32 v197, a9
    v_accvgpr_read_b32 v198, a10
    v_accvgpr_read_b32 v199, a11
    v_cvt_pk_bf16_f32 v168, v196, v197
    v_cvt_pk_bf16_f32 v169, v198, v199
    v_accvgpr_read_b32 v196, a24
    v_accvgpr_read_b32 v197, a25
    v_accvgpr_read_b32 v198, a26
    v_accvgpr_read_b32 v199, a27
    v_cvt_pk_bf16_f32 v170, v196, v197
    v_cvt_pk_bf16_f32 v171, v198, v199
    v_accvgpr_read_b32 v196, a40
    v_accvgpr_read_b32 v197, a41
    v_accvgpr_read_b32 v198, a42
    v_accvgpr_read_b32 v199, a43
    v_cvt_pk_bf16_f32 v172, v196, v197
    v_cvt_pk_bf16_f32 v173, v198, v199
    v_accvgpr_read_b32 v196, a56
    v_accvgpr_read_b32 v197, a57
    v_accvgpr_read_b32 v198, a58
    v_accvgpr_read_b32 v199, a59
    v_cvt_pk_bf16_f32 v174, v196, v197
    v_cvt_pk_bf16_f32 v175, v198, v199
    buffer_store_dwordx4 v[168:171], v140, s[16:19], s69 offen offset:0 sc0 sc1
    buffer_store_dwordx4 v[172:175], v140, s[16:19], s69 offen offset:1024 sc0 sc1
    v_accvgpr_read_b32 v196, a12
    v_accvgpr_read_b32 v197, a13
    v_accvgpr_read_b32 v198, a14
    v_accvgpr_read_b32 v199, a15
    v_cvt_pk_bf16_f32 v176, v196, v197
    v_cvt_pk_bf16_f32 v177, v198, v199
    v_accvgpr_read_b32 v196, a28
    v_accvgpr_read_b32 v197, a29
    v_accvgpr_read_b32 v198, a30
    v_accvgpr_read_b32 v199, a31
    v_cvt_pk_bf16_f32 v178, v196, v197
    v_cvt_pk_bf16_f32 v179, v198, v199
    v_accvgpr_read_b32 v196, a44
    v_accvgpr_read_b32 v197, a45
    v_accvgpr_read_b32 v198, a46
    v_accvgpr_read_b32 v199, a47
    v_cvt_pk_bf16_f32 v180, v196, v197
    v_cvt_pk_bf16_f32 v181, v198, v199
    v_accvgpr_read_b32 v196, a60
    v_accvgpr_read_b32 v197, a61
    v_accvgpr_read_b32 v198, a62
    v_accvgpr_read_b32 v199, a63
    v_cvt_pk_bf16_f32 v182, v196, v197
    v_cvt_pk_bf16_f32 v183, v198, v199
    buffer_store_dwordx4 v[176:179], v140, s[16:19], s70 offen offset:0 sc0 sc1
    buffer_store_dwordx4 v[180:183], v140, s[16:19], s70 offen offset:1024 sc0 sc1
    v_accvgpr_read_b32 v16, a4
    v_accvgpr_read_b32 v17, a5
    v_accvgpr_read_b32 v18, a6
    v_accvgpr_read_b32 v19, a7
    v_accvgpr_read_b32 v20, a20
    v_accvgpr_read_b32 v21, a21
    v_accvgpr_read_b32 v22, a22
    v_accvgpr_read_b32 v23, a23
    v_accvgpr_read_b32 v24, a36
    v_accvgpr_read_b32 v25, a37
    v_accvgpr_read_b32 v26, a38
    v_accvgpr_read_b32 v27, a39
    v_accvgpr_read_b32 v28, a52
    v_accvgpr_read_b32 v29, a53
    v_accvgpr_read_b32 v30, a54
    v_accvgpr_read_b32 v31, a55
    s_mov_b32 s78, s68
    s_add_u32 s67, s29, 1
    s_branch L_pubdoneg
L_pub2g:
    v_accvgpr_read_b32 v196, a0
    v_accvgpr_read_b32 v197, a1
    v_accvgpr_read_b32 v198, a2
    v_accvgpr_read_b32 v199, a3
    v_cvt_pk_bf16_f32 v160, v196, v197
    v_cvt_pk_bf16_f32 v161, v198, v199
    v_accvgpr_read_b32 v196, a16
    v_accvgpr_read_b32 v197, a17
    v_accvgpr_read_b32 v198, a18
    v_accvgpr_read_b32 v199, a19
    v_cvt_pk_bf16_f32 v162, v196, v197
    v_cvt_pk_bf16_f32 v163, v198, v199
    v_accvgpr_read_b32 v196, a32
    v_accvgpr_read_b32 v197, a33
    v_accvgpr_read_b32 v198, a34
    v_accvgpr_read_b32 v199, a35
    v_cvt_pk_bf16_f32 v164, v196, v197
    v_cvt_pk_bf16_f32 v165, v198, v199
    v_accvgpr_read_b32 v196, a48
    v_accvgpr_read_b32 v197, a49
    v_accvgpr_read_b32 v198, a50
    v_accvgpr_read_b32 v199, a51
    v_cvt_pk_bf16_f32 v166, v196, v197
    v_cvt_pk_bf16_f32 v167, v198, v199
    buffer_store_dwordx4 v[160:163], v140, s[16:19], s71 offen offset:0 sc0 sc1
    buffer_store_dwordx4 v[164:167], v140, s[16:19], s71 offen offset:1024 sc0 sc1
    v_accvgpr_read_b32 v196, a4
    v_accvgpr_read_b32 v197, a5
    v_accvgpr_read_b32 v198, a6
    v_accvgpr_read_b32 v199, a7
    v_cvt_pk_bf16_f32 v168, v196, v197
    v_cvt_pk_bf16_f32 v169, v198, v199
    v_accvgpr_read_b32 v196, a20
    v_accvgpr_read_b32 v197, a21
    v_accvgpr_read_b32 v198, a22
    v_accvgpr_read_b32 v199, a23
    v_cvt_pk_bf16_f32 v170, v196, v197
    v_cvt_pk_bf16_f32 v171, v198, v199
    v_accvgpr_read_b32 v196, a36
    v_accvgpr_read_b32 v197, a37
    v_accvgpr_read_b32 v198, a38
    v_accvgpr_read_b32 v199, a39
    v_cvt_pk_bf16_f32 v172, v196, v197
    v_cvt_pk_bf16_f32 v173, v198, v199
    v_accvgpr_read_b32 v196, a52
    v_accvgpr_read_b32 v197, a53
    v_accvgpr_read_b32 v198, a54
    v_accvgpr_read_b32 v199, a55
    v_cvt_pk_bf16_f32 v174, v196, v197
    v_cvt_pk_bf16_f32 v175, v198, v199
    buffer_store_dwordx4 v[168:171], v140, s[16:19], s68 offen offset:0 sc0 sc1
    buffer_store_dwordx4 v[172:175], v140, s[16:19], s68 offen offset:1024 sc0 sc1
    v_accvgpr_read_b32 v196, a12
    v_accvgpr_read_b32 v197, a13
    v_accvgpr_read_b32 v198, a14
    v_accvgpr_read_b32 v199, a15
    v_cvt_pk_bf16_f32 v176, v196, v197
    v_cvt_pk_bf16_f32 v177, v198, v199
    v_accvgpr_read_b32 v196, a28
    v_accvgpr_read_b32 v197, a29
    v_accvgpr_read_b32 v198, a30
    v_accvgpr_read_b32 v199, a31
    v_cvt_pk_bf16_f32 v178, v196, v197
    v_cvt_pk_bf16_f32 v179, v198, v199
    v_accvgpr_read_b32 v196, a44
    v_accvgpr_read_b32 v197, a45
    v_accvgpr_read_b32 v198, a46
    v_accvgpr_read_b32 v199, a47
    v_cvt_pk_bf16_f32 v180, v196, v197
    v_cvt_pk_bf16_f32 v181, v198, v199
    v_accvgpr_read_b32 v196, a60
    v_accvgpr_read_b32 v197, a61
    v_accvgpr_read_b32 v198, a62
    v_accvgpr_read_b32 v199, a63
    v_cvt_pk_bf16_f32 v182, v196, v197
    v_cvt_pk_bf16_f32 v183, v198, v199
    buffer_store_dwordx4 v[176:179], v140, s[16:19], s70 offen offset:0 sc0 sc1
    buffer_store_dwordx4 v[180:183], v140, s[16:19], s70 offen offset:1024 sc0 sc1
    v_accvgpr_read_b32 v16, a8
    v_accvgpr_read_b32 v17, a9
    v_accvgpr_read_b32 v18, a10
    v_accvgpr_read_b32 v19, a11
    v_accvgpr_read_b32 v20, a24
    v_accvgpr_read_b32 v21, a25
    v_accvgpr_read_b32 v22, a26
    v_accvgpr_read_b32 v23, a27
    v_accvgpr_read_b32 v24, a40
    v_accvgpr_read_b32 v25, a41
    v_accvgpr_read_b32 v26, a42
    v_accvgpr_read_b32 v27, a43
    v_accvgpr_read_b32 v28, a56
    v_accvgpr_read_b32 v29, a57
    v_accvgpr_read_b32 v30, a58
    v_accvgpr_read_b32 v31, a59
    s_mov_b32 s78, s69
    s_add_u32 s67, s30, 1
    s_branch L_pubdoneg
L_pub3g:
    v_accvgpr_read_b32 v196, a0
    v_accvgpr_read_b32 v197, a1
    v_accvgpr_read_b32 v198, a2
    v_accvgpr_read_b32 v199, a3
    v_cvt_pk_bf16_f32 v160, v196, v197
    v_cvt_pk_bf16_f32 v161, v198, v199
    v_accvgpr_read_b32 v196, a16
    v_accvgpr_read_b32 v197, a17
    v_accvgpr_read_b32 v198, a18
    v_accvgpr_read_b32 v199, a19
    v_cvt_pk_bf16_f32 v162, v196, v197
    v_cvt_pk_bf16_f32 v163, v198, v199
    v_accvgpr_read_b32 v196, a32
    v_accvgpr_read_b32 v197, a33
    v_accvgpr_read_b32 v198, a34
    v_accvgpr_read_b32 v199, a35
    v_cvt_pk_bf16_f32 v164, v196, v197
    v_cvt_pk_bf16_f32 v165, v198, v199
    v_accvgpr_read_b32 v196, a48
    v_accvgpr_read_b32 v197, a49
    v_accvgpr_read_b32 v198, a50
    v_accvgpr_read_b32 v199, a51
    v_cvt_pk_bf16_f32 v166, v196, v197
    v_cvt_pk_bf16_f32 v167, v198, v199
    buffer_store_dwordx4 v[160:163], v140, s[16:19], s71 offen offset:0 sc0 sc1
    buffer_store_dwordx4 v[164:167], v140, s[16:19], s71 offen offset:1024 sc0 sc1
    v_accvgpr_read_b32 v196, a4
    v_accvgpr_read_b32 v197, a5
    v_accvgpr_read_b32 v198, a6
    v_accvgpr_read_b32 v199, a7
    v_cvt_pk_bf16_f32 v168, v196, v197
    v_cvt_pk_bf16_f32 v169, v198, v199
    v_accvgpr_read_b32 v196, a20
    v_accvgpr_read_b32 v197, a21
    v_accvgpr_read_b32 v198, a22
    v_accvgpr_read_b32 v199, a23
    v_cvt_pk_bf16_f32 v170, v196, v197
    v_cvt_pk_bf16_f32 v171, v198, v199
    v_accvgpr_read_b32 v196, a36
    v_accvgpr_read_b32 v197, a37
    v_accvgpr_read_b32 v198, a38
    v_accvgpr_read_b32 v199, a39
    v_cvt_pk_bf16_f32 v172, v196, v197
    v_cvt_pk_bf16_f32 v173, v198, v199
    v_accvgpr_read_b32 v196, a52
    v_accvgpr_read_b32 v197, a53
    v_accvgpr_read_b32 v198, a54
    v_accvgpr_read_b32 v199, a55
    v_cvt_pk_bf16_f32 v174, v196, v197
    v_cvt_pk_bf16_f32 v175, v198, v199
    buffer_store_dwordx4 v[168:171], v140, s[16:19], s68 offen offset:0 sc0 sc1
    buffer_store_dwordx4 v[172:175], v140, s[16:19], s68 offen offset:1024 sc0 sc1
    v_accvgpr_read_b32 v196, a8
    v_accvgpr_read_b32 v197, a9
    v_accvgpr_read_b32 v198, a10
    v_accvgpr_read_b32 v199, a11
    v_cvt_pk_bf16_f32 v176, v196, v197
    v_cvt_pk_bf16_f32 v177, v198, v199
    v_accvgpr_read_b32 v196, a24
    v_accvgpr_read_b32 v197, a25
    v_accvgpr_read_b32 v198, a26
    v_accvgpr_read_b32 v199, a27
    v_cvt_pk_bf16_f32 v178, v196, v197
    v_cvt_pk_bf16_f32 v179, v198, v199
    v_accvgpr_read_b32 v196, a40
    v_accvgpr_read_b32 v197, a41
    v_accvgpr_read_b32 v198, a42
    v_accvgpr_read_b32 v199, a43
    v_cvt_pk_bf16_f32 v180, v196, v197
    v_cvt_pk_bf16_f32 v181, v198, v199
    v_accvgpr_read_b32 v196, a56
    v_accvgpr_read_b32 v197, a57
    v_accvgpr_read_b32 v198, a58
    v_accvgpr_read_b32 v199, a59
    v_cvt_pk_bf16_f32 v182, v196, v197
    v_cvt_pk_bf16_f32 v183, v198, v199
    buffer_store_dwordx4 v[176:179], v140, s[16:19], s69 offen offset:0 sc0 sc1
    buffer_store_dwordx4 v[180:183], v140, s[16:19], s69 offen offset:1024 sc0 sc1
    v_accvgpr_read_b32 v16, a12
    v_accvgpr_read_b32 v17, a13
    v_accvgpr_read_b32 v18, a14
    v_accvgpr_read_b32 v19, a15
    v_accvgpr_read_b32 v20, a28
    v_accvgpr_read_b32 v21, a29
    v_accvgpr_read_b32 v22, a30
    v_accvgpr_read_b32 v23, a31
    v_accvgpr_read_b32 v24, a44
    v_accvgpr_read_b32 v25, a45
    v_accvgpr_read_b32 v26, a46
    v_accvgpr_read_b32 v27, a47
    v_accvgpr_read_b32 v28, a60
    v_accvgpr_read_b32 v29, a61
    v_accvgpr_read_b32 v30, a62
    v_accvgpr_read_b32 v31, a63
    s_mov_b32 s78, s70
    s_add_u32 s67, s31, 1
L_pubdoneg:
    s_mov_b32 exec_hi, 0
    buffer_store_dwordx2 v[32:33], v141, s[16:19], s71 offen sc0 sc1
    s_mov_b64 exec, -1
    v_mov_b32 v15, s67
    s_cmp_lg_u32 s66, 0
    s_cbranch_scc1 L_early
    s_branch L_noab
L_early:
    v_cvt_pk_bf16_f32 v184, v16, v17
    v_cvt_pk_bf16_f32 v185, v18, v19
    v_cvt_pk_bf16_f32 v186, v20, v21
    v_cvt_pk_bf16_f32 v187, v22, v23
    v_cvt_pk_bf16_f32 v188, v24, v25
    v_cvt_pk_bf16_f32 v189, v26, v27
    v_cvt_pk_bf16_f32 v190, v28, v29
    v_cvt_pk_bf16_f32 v191, v30, v31
    buffer_store_dwordx4 v[184:187], v140, s[16:19], s78 offen offset:0 sc0 sc1
    buffer_store_dwordx4 v[188:191], v140, s[16:19], s78 offen offset:1024 sc0 sc1
    s_waitcnt vmcnt(0)
    s_barrier
    v_mov_b32 v58, 56352
    s_cmp_lg_u32 s3, 0
    s_cbranch_scc1 L_early2
    s_add_u32 s78, s61, 3
    s_lshl_b32 s78, 1, s78
    v_mov_b32 v56, s78
    v_mov_b32 v57, 0
    s_mov_b64 exec, 1
    buffer_atomic_add v56, v57, s[20:23], 0 offen sc0 sc1
    s_waitcnt vmcnt(0)
    ds_write_b32 v58, v56
    s_mov_b64 exec, -1
    s_waitcnt lgkmcnt(0)
L_early2:
    s_barrier
    ds_read_b32 v56, v58
    s_waitcnt lgkmcnt(0)
    v_readfirstlane_b32 s66, v56
    s_nop 3
    s_and_b32 s66, s66, 7
    s_cmp_lg_u32 s66, 4
    s_cselect_b32 s66, 1, 0
L_noab:
    s_waitcnt vmcnt(0)
    s_mov_b64 exec, 1
    buffer_store_dword v15, v143, s[16:19], s36 offen sc0 sc1
    s_mov_b64 exec, -1
    s_cmp_lg_u32 s66, 0
    s_cbranch_scc1 L_end
    s_mov_b32 s69, s34
    v_readfirstlane_b32 s68, v148
    s_nop 3
    s_cmp_lg_u32 s68, s28
    s_cselect_b32 s68, 1, 0
    s_or_b32 s69, s69, s68
    v_readfirstlane_b32 s68, v149
    s_nop 3
    s_cmp_lg_u32 s68, s29
    s_cselect_b32 s68, 2, 0
    s_or_b32 s69, s69, s68
    v_readfirstlane_b32 s68, v150
    s_nop 3
    s_cmp_lg_u32 s68, s30
    s_cselect_b32 s68, 4, 0
    s_or_b32 s69, s69, s68
    v_readfirstlane_b32 s68, v151
    s_nop 3
    s_cmp_lg_u32 s68, s31
    s_cselect_b32 s68, 8, 0
    s_or_b32 s69, s69, s68
    s_cmp_eq_u32 s69, 15
    s_cbranch_scc1 L_go
L_wait:
    s_mov_b32 s71, 0
L_poll:
    buffer_load_dwordx4 v[148:151], v143, s[16:19], 0 offen sc1
    s_waitcnt vmcnt(0)
    s_mov_b32 s69, s34
    v_readfirstlane_b32 s68, v148
    s_nop 3
    s_cmp_lg_u32 s68, s28
    s_cselect_b32 s68, 1, 0
    s_or_b32 s69, s69, s68
    v_readfirstlane_b32 s68, v149
    s_nop 3
    s_cmp_lg_u32 s68, s29
    s_cselect_b32 s68, 2, 0
    s_or_b32 s69, s69, s68
    v_readfirstlane_b32 s68, v150
    s_nop 3
    s_cmp_lg_u32 s68, s30
    s_cselect_b32 s68, 4, 0
    s_or_b32 s69, s69, s68
    v_readfirstlane_b32 s68, v151
    s_nop 3
    s_cmp_lg_u32 s68, s31
    s_cselect_b32 s68, 8, 0
    s_or_b32 s69, s69, s68
    s_cmp_eq_u32 s69, 15
    s_cbranch_scc1 L_go
    s_sleep 1
    s_add_u32 s71, s71, 1
    s_cmp_lt_u32 s71, 0x400000
    s_cbranch_scc1 L_poll
L_go:
    s_add_u32 s68, s61, 1
    s_and_b32 s68, s68, 3
    s_mul_i32 s68, s68, 69632
    s_add_u32 s69, s61, 2
    s_and_b32 s69, s69, 3
    s_mul_i32 s69, s69, 69632
    s_add_u32 s70, s61, 3
    s_and_b32 s70, s70, 3
    s_mul_i32 s70, s70, 69632
    s_mov_b32 s79, s61
    buffer_load_dwordx2 v[36:37], v141, s[16:19], s68 offen sc1
    buffer_load_dwordx2 v[40:41], v141, s[16:19], s69 offen sc1
    buffer_load_dwordx2 v[44:45], v141, s[16:19], s70 offen sc1
    s_lshl_b32 s78, s79, 12
    s_add_u32 s68, s68, s78
    s_add_u32 s69, s69, s78
    s_add_u32 s70, s70, s78
    buffer_load_dwordx4 v[160:163], v140, s[16:19], s68 offen offset:0 sc1
    buffer_load_dwordx4 v[164:167], v140, s[16:19], s68 offen offset:1024 sc1
    buffer_load_dwordx4 v[168:171], v140, s[16:19], s69 offen offset:0 sc1
    buffer_load_dwordx4 v[172:175], v140, s[16:19], s69 offen offset:1024 sc1
    buffer_load_dwordx4 v[176:179], v140, s[16:19], s70 offen offset:0 sc1
    buffer_load_dwordx4 v[180:183], v140, s[16:19], s70 offen offset:1024 sc1
    s_waitcnt vmcnt(6)
    v_max3_f32 v60, v36, v40, v44
    v_max_f32 v60, v60, v32
    v_sub_f32 v56, v36, v60
    v_sub_f32 v57, v40, v60
    v_sub_f32 v58, v44, v60
    v_sub_f32 v59, v32, v60
    v_mul_f32 v56, s65, v56
    v_mul_f32 v57, s65, v57
    v_mul_f32 v58, s65, v58
    v_mul_f32 v59, s65, v59
    v_exp_f32 v56, v56
    v_exp_f32 v57, v57
    v_exp_f32 v58, v58
    v_exp_f32 v59, v59
    s_nop 0
    v_mul_f32 v60, v56, v37
    v_fma_f32 v60, v57, v41, v60
    v_fma_f32 v60, v58, v45, v60
    v_fma_f32 v60, v59, v33, v60
    v_rcp_f32 v60, v60
    s_nop 0
    v_mul_f32 v56, v56, v60
    v_mul_f32 v57, v57, v60
    v_mul_f32 v58, v58, v60
    v_mul_f32 v59, v59, v60
    v_mul_f32 v16, v16, v59
    v_mul_f32 v17, v17, v59
    v_mul_f32 v18, v18, v59
    v_mul_f32 v19, v19, v59
    v_mul_f32 v20, v20, v59
    v_mul_f32 v21, v21, v59
    v_mul_f32 v22, v22, v59
    v_mul_f32 v23, v23, v59
    v_mul_f32 v24, v24, v59
    v_mul_f32 v25, v25, v59
    v_mul_f32 v26, v26, v59
    v_mul_f32 v27, v27, v59
    v_mul_f32 v28, v28, v59
    v_mul_f32 v29, v29, v59
    v_mul_f32 v30, v30, v59
    v_mul_f32 v31, v31, v59
    s_waitcnt vmcnt(4)
    v_lshlrev_b32 v64, 16, v160
    v_and_b32 v65, 0xffff0000, v160
    v_lshlrev_b32 v66, 16, v161
    v_and_b32 v67, 0xffff0000, v161
    v_lshlrev_b32 v68, 16, v162
    v_and_b32 v69, 0xffff0000, v162
    v_lshlrev_b32 v70, 16, v163
    v_and_b32 v71, 0xffff0000, v163
    v_lshlrev_b32 v72, 16, v164
    v_and_b32 v73, 0xffff0000, v164
    v_lshlrev_b32 v74, 16, v165
    v_and_b32 v75, 0xffff0000, v165
    v_lshlrev_b32 v76, 16, v166
    v_and_b32 v77, 0xffff0000, v166
    v_lshlrev_b32 v78, 16, v167
    v_and_b32 v79, 0xffff0000, v167
    v_fma_f32 v16, v64, v56, v16
    v_fma_f32 v17, v65, v56, v17
    v_fma_f32 v18, v66, v56, v18
    v_fma_f32 v19, v67, v56, v19
    v_fma_f32 v20, v68, v56, v20
    v_fma_f32 v21, v69, v56, v21
    v_fma_f32 v22, v70, v56, v22
    v_fma_f32 v23, v71, v56, v23
    v_fma_f32 v24, v72, v56, v24
    v_fma_f32 v25, v73, v56, v25
    v_fma_f32 v26, v74, v56, v26
    v_fma_f32 v27, v75, v56, v27
    v_fma_f32 v28, v76, v56, v28
    v_fma_f32 v29, v77, v56, v29
    v_fma_f32 v30, v78, v56, v30
    v_fma_f32 v31, v79, v56, v31
    s_waitcnt vmcnt(2)
    v_lshlrev_b32 v80, 16, v168
    v_and_b32 v81, 0xffff0000, v168
    v_lshlrev_b32 v82, 16, v169
    v_and_b32 v83, 0xffff0000, v169
    v_lshlrev_b32 v84, 16, v170
    v_and_b32 v85, 0xffff0000, v170
    v_lshlrev_b32 v86, 16, v171
    v_and_b32 v87, 0xffff0000, v171
    v_lshlrev_b32 v88, 16, v172
    v_and_b32 v89, 0xffff0000, v172
    v_lshlrev_b32 v90, 16, v173
    v_and_b32 v91, 0xffff0000, v173
    v_lshlrev_b32 v92, 16, v174
    v_and_b32 v93, 0xffff0000, v174
    v_lshlrev_b32 v94, 16, v175
    v_and_b32 v95, 0xffff0000, v175
    v_fma_f32 v16, v80, v57, v16
    v_fma_f32 v17, v81, v57, v17
    v_fma_f32 v18, v82, v57, v18
    v_fma_f32 v19, v83, v57, v19
    v_fma_f32 v20, v84, v57, v20
    v_fma_f32 v21, v85, v57, v21
    v_fma_f32 v22, v86, v57, v22
    v_fma_f32 v23, v87, v57, v23
    v_fma_f32 v24, v88, v57, v24
    v_fma_f32 v25, v89, v57, v25
    v_fma_f32 v26, v90, v57, v26
    v_fma_f32 v27, v91, v57, v27
    v_fma_f32 v28, v92, v57, v28
    v_fma_f32 v29, v93, v57, v29
    v_fma_f32 v30, v94, v57, v30
    v_fma_f32 v31, v95, v57, v31
    s_waitcnt vmcnt(0)
    v_lshlrev_b32 v96, 16, v176
    v_and_b32 v97, 0xffff0000, v176
    v_lshlrev_b32 v98, 16, v177
    v_and_b32 v99, 0xffff0000, v177
    v_lshlrev_b32 v100, 16, v178
    v_and_b32 v101, 0xffff0000, v178
    v_lshlrev_b32 v102, 16, v179
    v_and_b32 v103, 0xffff0000, v179
    v_lshlrev_b32 v104, 16, v180
    v_and_b32 v105, 0xffff0000, v180
    v_lshlrev_b32 v106, 16, v181
    v_and_b32 v107, 0xffff0000, v181
    v_lshlrev_b32 v108, 16, v182
    v_and_b32 v109, 0xffff0000, v182
    v_lshlrev_b32 v110, 16, v183
    v_and_b32 v111, 0xffff0000, v183
    v_fma_f32 v16, v96, v58, v16
    v_fma_f32 v17, v97, v58, v17
    v_fma_f32 v18, v98, v58, v18
    v_fma_f32 v19, v99, v58, v19
    v_fma_f32 v20, v100, v58, v20
    v_fma_f32 v21, v101, v58, v21
    v_fma_f32 v22, v102, v58, v22
    v_fma_f32 v23, v103, v58, v23
    v_fma_f32 v24, v104, v58, v24
    v_fma_f32 v25, v105, v58, v25
    v_fma_f32 v26, v106, v58, v26
    v_fma_f32 v27, v107, v58, v27
    v_fma_f32 v28, v108, v58, v28
    v_fma_f32 v29, v109, v58, v29
    v_fma_f32 v30, v110, v58, v30
    v_fma_f32 v31, v111, v58, v31
    v_cvt_pk_bf16_f32 v128, v16, v20
    v_cvt_pk_bf16_f32 v129, v24, v28
    v_cvt_pk_bf16_f32 v130, v17, v21
    v_cvt_pk_bf16_f32 v131, v25, v29
    v_cvt_pk_bf16_f32 v132, v18, v22
    v_cvt_pk_bf16_f32 v133, v26, v30
    v_cvt_pk_bf16_f32 v134, v19, v23
    v_cvt_pk_bf16_f32 v135, v27, v31
    s_lshl_b32 s78, s79, 6
    buffer_store_dwordx4 v[128:131], v142, s[72:75], s78 offen
    buffer_store_dwordx4 v[132:135], v142, s[72:75], s78 offen offset:16
    s_mov_b32 s79, -1
L_abloop:
    s_cmp_eq_u32 s35, 0
    s_cbranch_scc1 L_fin
    s_and_b32 s68, s35, 1
    s_lshr_b32 s35, s35, 1
    s_add_u32 s79, s79, 1
    s_cmp_eq_u32 s68, 0
    s_cbranch_scc1 L_abloop
    s_waitcnt vmcnt(0)
    s_mov_b32 s68, 0
    s_mov_b32 s69, 69632
    s_mov_b32 s70, 139264
    s_mov_b32 s71, 208896
    buffer_load_dwordx2 v[36:37], v141, s[16:19], s68 offen sc1
    buffer_load_dwordx2 v[40:41], v141, s[16:19], s69 offen sc1
    buffer_load_dwordx2 v[44:45], v141, s[16:19], s70 offen sc1
    buffer_load_dwordx2 v[48:49], v141, s[16:19], s71 offen sc1
    s_lshl_b32 s78, s79, 12
    s_add_u32 s68, s68, s78
    s_add_u32 s69, s69, s78
    s_add_u32 s70, s70, s78
    s_add_u32 s71, s71, s78
    buffer_load_dwordx4 v[160:163], v140, s[16:19], s68 offen offset:0 sc1
    buffer_load_dwordx4 v[164:167], v140, s[16:19], s68 offen offset:1024 sc1
    buffer_load_dwordx4 v[168:171], v140, s[16:19], s69 offen offset:0 sc1
    buffer_load_dwordx4 v[172:175], v140, s[16:19], s69 offen offset:1024 sc1
    buffer_load_dwordx4 v[176:179], v140, s[16:19], s70 offen offset:0 sc1
    buffer_load_dwordx4 v[180:183], v140, s[16:19], s70 offen offset:1024 sc1
    buffer_load_dwordx4 v[184:187], v140, s[16:19], s71 offen offset:0 sc1
    buffer_load_dwordx4 v[188:191], v140, s[16:19], s71 offen offset:1024 sc1
    s_waitcnt vmcnt(8)
    v_max3_f32 v60, v36, v40, v44
    v_max_f32 v60, v60, v48
    v_sub_f32 v56, v36, v60
    v_sub_f32 v57, v40, v60
    v_sub_f32 v58, v44, v60
    v_sub_f32 v59, v48, v60
    v_mul_f32 v56, s65, v56
    v_mul_f32 v57, s65, v57
    v_mul_f32 v58, s65, v58
    v_mul_f32 v59, s65, v59
    v_exp_f32 v56, v56
    v_exp_f32 v57, v57
    v_exp_f32 v58, v58
    v_exp_f32 v59, v59
    s_nop 0
    v_mul_f32 v60, v56, v37
    v_fma_f32 v60, v57, v41, v60
    v_fma_f32 v60, v58, v45, v60
    v_fma_f32 v60, v59, v49, v60
    v_rcp_f32 v60, v60
    s_nop 0
    v_mul_f32 v56, v56, v60
    v_mul_f32 v57, v57, v60
    v_mul_f32 v58, v58, v60
    v_mul_f32 v59, v59, v60
    s_waitcnt vmcnt(6)
    v_lshlrev_b32 v64, 16, v160
    v_and_b32 v65, 0xffff0000, v160
    v_lshlrev_b32 v66, 16, v161
    v_and_b32 v67, 0xffff0000, v161
    v_lshlrev_b32 v68, 16, v162
    v_and_b32 v69, 0xffff0000, v162
    v_lshlrev_b32 v70, 16, v163
    v_and_b32 v71, 0xffff0000, v163
    v_lshlrev_b32 v72, 16, v164
    v_and_b32 v73, 0xffff0000, v164
    v_lshlrev_b32 v74, 16, v165
    v_and_b32 v75, 0xffff0000, v165
    v_lshlrev_b32 v76, 16, v166
    v_and_b32 v77, 0xffff0000, v166
    v_lshlrev_b32 v78, 16, v167
    v_and_b32 v79, 0xffff0000, v167
    v_mul_f32 v64, v64, v56
    v_mul_f32 v65, v65, v56
    v_mul_f32 v66, v66, v56
    v_mul_f32 v67, v67, v56
    v_mul_f32 v68, v68, v56
    v_mul_f32 v69, v69, v56
    v_mul_f32 v70, v70, v56
    v_mul_f32 v71, v71, v56
    v_mul_f32 v72, v72, v56
    v_mul_f32 v73, v73, v56
    v_mul_f32 v74, v74, v56
    v_mul_f32 v75, v75, v56
    v_mul_f32 v76, v76, v56
    v_mul_f32 v77, v77, v56
    v_mul_f32 v78, v78, v56
    v_mul_f32 v79, v79, v56
    s_waitcnt vmcnt(4)
    v_lshlrev_b32 v80, 16, v168
    v_and_b32 v81, 0xffff0000, v168
    v_lshlrev_b32 v82, 16, v169
    v_and_b32 v83, 0xffff0000, v169
    v_lshlrev_b32 v84, 16, v170
    v_and_b32 v85, 0xffff0000, v170
    v_lshlrev_b32 v86, 16, v171
    v_and_b32 v87, 0xffff0000, v171
    v_lshlrev_b32 v88, 16, v172
    v_and_b32 v89, 0xffff0000, v172
    v_lshlrev_b32 v90, 16, v173
    v_and_b32 v91, 0xffff0000, v173
    v_lshlrev_b32 v92, 16, v174
    v_and_b32 v93, 0xffff0000, v174
    v_lshlrev_b32 v94, 16, v175
    v_and_b32 v95, 0xffff0000, v175
    v_fma_f32 v64, v80, v57, v64
    v_fma_f32 v65, v81, v57, v65
    v_fma_f32 v66, v82, v57, v66
    v_fma_f32 v67, v83, v57, v67
    v_fma_f32 v68, v84, v57, v68
    v_fma_f32 v69, v85, v57, v69
    v_fma_f32 v70, v86, v57, v70
    v_fma_f32 v71, v87, v57, v71
    v_fma_f32 v72, v88, v57, v72
    v_fma_f32 v73, v89, v57, v73
    v_fma_f32 v74, v90, v57, v74
    v_fma_f32 v75, v91, v57, v75
    v_fma_f32 v76, v92, v57, v76
    v_fma_f32 v77, v93, v57, v77
    v_fma_f32 v78, v94, v57, v78
    v_fma_f32 v79, v95, v57, v79
    s_waitcnt vmcnt(2)
    v_lshlrev_b32 v96, 16, v176
    v_and_b32 v97, 0xffff0000, v176
    v_lshlrev_b32 v98, 16, v177
    v_and_b32 v99, 0xffff0000, v177
    v_lshlrev_b32 v100, 16, v178
    v_and_b32 v101, 0xffff0000, v178
    v_lshlrev_b32 v102, 16, v179
    v_and_b32 v103, 0xffff0000, v179
    v_lshlrev_b32 v104, 16, v180
    v_and_b32 v105, 0xffff0000, v180
    v_lshlrev_b32 v106, 16, v181
    v_and_b32 v107, 0xffff0000, v181
    v_lshlrev_b32 v108, 16, v182
    v_and_b32 v109, 0xffff0000, v182
    v_lshlrev_b32 v110, 16, v183
    v_and_b32 v111, 0xffff0000, v183
    v_fma_f32 v64, v96, v58, v64
    v_fma_f32 v65, v97, v58, v65
    v_fma_f32 v66, v98, v58, v66
    v_fma_f32 v67, v99, v58, v67
    v_fma_f32 v68, v100, v58, v68
    v_fma_f32 v69, v101, v58, v69
    v_fma_f32 v70, v102, v58, v70
    v_fma_f32 v71, v103, v58, v71
    v_fma_f32 v72, v104, v58, v72
    v_fma_f32 v73, v105, v58, v73
    v_fma_f32 v74, v106, v58, v74
    v_fma_f32 v75, v107, v58, v75
    v_fma_f32 v76, v108, v58, v76
    v_fma_f32 v77, v109, v58, v77
    v_fma_f32 v78, v110, v58, v78
    v_fma_f32 v79, v111, v58, v79
    s_waitcnt vmcnt(0)
    v_lshlrev_b32 v112, 16, v184
    v_and_b32 v113, 0xffff0000, v184
    v_lshlrev_b32 v114, 16, v185
    v_and_b32 v115, 0xffff0000, v185
    v_lshlrev_b32 v116, 16, v186
    v_and_b32 v117, 0xffff0000, v186
    v_lshlrev_b32 v118, 16, v187
    v_and_b32 v119, 0xffff0000, v187
    v_lshlrev_b32 v120, 16, v188
    v_and_b32 v121, 0xffff0000, v188
    v_lshlrev_b32 v122, 16, v189
    v_and_b32 v123, 0xffff0000, v189
    v_lshlrev_b32 v124, 16, v190
    v_and_b32 v125, 0xffff0000, v190
    v_lshlrev_b32 v126, 16, v191
    v_and_b32 v127, 0xffff0000, v191
    v_fma_f32 v64, v112, v59, v64
    v_fma_f32 v65, v113, v59, v65
    v_fma_f32 v66, v114, v59, v66
    v_fma_f32 v67, v115, v59, v67
    v_fma_f32 v68, v116, v59, v68
    v_fma_f32 v69, v117, v59, v69
    v_fma_f32 v70, v118, v59, v70
    v_fma_f32 v71, v119, v59, v71
    v_fma_f32 v72, v120, v59, v72
    v_fma_f32 v73, v121, v59, v73
    v_fma_f32 v74, v122, v59, v74
    v_fma_f32 v75, v123, v59, v75
    v_fma_f32 v76, v124, v59, v76
    v_fma_f32 v77, v125, v59, v77
    v_fma_f32 v78, v126, v59, v78
    v_fma_f32 v79, v127, v59, v79
    v_cvt_pk_bf16_f32 v128, v64, v68
    v_cvt_pk_bf16_f32 v129, v72, v76
    v_cvt_pk_bf16_f32 v130, v65, v69
    v_cvt_pk_bf16_f32 v131, v73, v77
    v_cvt_pk_bf16_f32 v132, v66, v70
    v_cvt_pk_bf16_f32 v133, v74, v78
    v_cvt_pk_bf16_f32 v134, v67, v71
    v_cvt_pk_bf16_f32 v135, v75, v79
    s_lshl_b32 s78, s79, 6
    buffer_store_dwordx4 v[128:131], v142, s[72:75], s78 offen
    buffer_store_dwordx4 v[132:135], v142, s[72:75], s78 offen offset:16
    s_branch L_abloop
L_fin:
    s_waitcnt vmcnt(0)
L_end:
    s_endpgm
L_resc_l:
    s_swappc_b64 s[26:27], s[24:25]
    s_branch L_back_l
L_resc_z:
    s_swappc_b64 s[26:27], s[24:25]
    s_branch L_back_z
L_rescale:
    v_max_f32 v15, v15, v10
    v_sub_f32 v120, v10, v15
    v_mul_f32 v120, s65, v120
    v_exp_f32 v120, v120
    v_mov_b32 v10, v15
    v_mul_f32 v11, s65, v15
    v_sub_f32 v11, 0, v11
    v_add_f32 v12, 0x427af233, v15
    v_mul_f32 v13, v13, v120
    v_mul_f32 v14, v14, v120
    s_nop 15
    s_nop 7
    v_accvgpr_read_b32 v208, a0
    v_accvgpr_read_b32 v209, a1
    v_accvgpr_read_b32 v210, a2
    v_accvgpr_read_b32 v211, a3
    v_mul_f32 v208, v208, v120
    v_mul_f32 v209, v209, v120
    v_mul_f32 v210, v210, v120
    v_mul_f32 v211, v211, v120
    v_accvgpr_write_b32 a0, v208
    v_accvgpr_write_b32 a1, v209
    v_accvgpr_write_b32 a2, v210
    v_accvgpr_write_b32 a3, v211
    v_accvgpr_read_b32 v208, a4
    v_accvgpr_read_b32 v209, a5
    v_accvgpr_read_b32 v210, a6
    v_accvgpr_read_b32 v211, a7
    v_mul_f32 v208, v208, v120
    v_mul_f32 v209, v209, v120
    v_mul_f32 v210, v210, v120
    v_mul_f32 v211, v211, v120
    v_accvgpr_write_b32 a4, v208
    v_accvgpr_write_b32 a5, v209
    v_accvgpr_write_b32 a6, v210
    v_accvgpr_write_b32 a7, v211
    v_accvgpr_read_b32 v208, a8
    v_accvgpr_read_b32 v209, a9
    v_accvgpr_read_b32 v210, a10
    v_accvgpr_read_b32 v211, a11
    v_mul_f32 v208, v208, v120
    v_mul_f32 v209, v209, v120
    v_mul_f32 v210, v210, v120
    v_mul_f32 v211, v211, v120
    v_accvgpr_write_b32 a8, v208
    v_accvgpr_write_b32 a9, v209
    v_accvgpr_write_b32 a10, v210
    v_accvgpr_write_b32 a11, v211
    v_accvgpr_read_b32 v208, a12
    v_accvgpr_read_b32 v209, a13
    v_accvgpr_read_b32 v210, a14
    v_accvgpr_read_b32 v211, a15
    v_mul_f32 v208, v208, v120
    v_mul_f32 v209, v209, v120
    v_mul_f32 v210, v210, v120
    v_mul_f32 v211, v211, v120
    v_accvgpr_write_b32 a12, v208
    v_accvgpr_write_b32 a13, v209
    v_accvgpr_write_b32 a14, v210
    v_accvgpr_write_b32 a15, v211
    v_accvgpr_read_b32 v208, a16
    v_accvgpr_read_b32 v209, a17
    v_accvgpr_read_b32 v210, a18
    v_accvgpr_read_b32 v211, a19
    v_mul_f32 v208, v208, v120
    v_mul_f32 v209, v209, v120
    v_mul_f32 v210, v210, v120
    v_mul_f32 v211, v211, v120
    v_accvgpr_write_b32 a16, v208
    v_accvgpr_write_b32 a17, v209
    v_accvgpr_write_b32 a18, v210
    v_accvgpr_write_b32 a19, v211
    v_accvgpr_read_b32 v208, a20
    v_accvgpr_read_b32 v209, a21
    v_accvgpr_read_b32 v210, a22
    v_accvgpr_read_b32 v211, a23
    v_mul_f32 v208, v208, v120
    v_mul_f32 v209, v209, v120
    v_mul_f32 v210, v210, v120
    v_mul_f32 v211, v211, v120
    v_accvgpr_write_b32 a20, v208
    v_accvgpr_write_b32 a21, v209
    v_accvgpr_write_b32 a22, v210
    v_accvgpr_write_b32 a23, v211
    v_accvgpr_read_b32 v208, a24
    v_accvgpr_read_b32 v209, a25
    v_accvgpr_read_b32 v210, a26
    v_accvgpr_read_b32 v211, a27
    v_mul_f32 v208, v208, v120
    v_mul_f32 v209, v209, v120
    v_mul_f32 v210, v210, v120
    v_mul_f32 v211, v211, v120
    v_accvgpr_write_b32 a24, v208
    v_accvgpr_write_b32 a25, v209
    v_accvgpr_write_b32 a26, v210
    v_accvgpr_write_b32 a27, v211
    v_accvgpr_read_b32 v208, a28
    v_accvgpr_read_b32 v209, a29
    v_accvgpr_read_b32 v210, a30
    v_accvgpr_read_b32 v211, a31
    v_mul_f32 v208, v208, v120
    v_mul_f32 v209, v209, v120
    v_mul_f32 v210, v210, v120
    v_mul_f32 v211, v211, v120
    v_accvgpr_write_b32 a28, v208
    v_accvgpr_write_b32 a29, v209
    v_accvgpr_write_b32 a30, v210
    v_accvgpr_write_b32 a31, v211
    v_accvgpr_read_b32 v208, a32
    v_accvgpr_read_b32 v209, a33
    v_accvgpr_read_b32 v210, a34
    v_accvgpr_read_b32 v211, a35
    v_mul_f32 v208, v208, v120
    v_mul_f32 v209, v209, v120
    v_mul_f32 v210, v210, v120
    v_mul_f32 v211, v211, v120
    v_accvgpr_write_b32 a32, v208
    v_accvgpr_write_b32 a33, v209
    v_accvgpr_write_b32 a34, v210
    v_accvgpr_write_b32 a35, v211
    v_accvgpr_read_b32 v208, a36
    v_accvgpr_read_b32 v209, a37
    v_accvgpr_read_b32 v210, a38
    v_accvgpr_read_b32 v211, a39
    v_mul_f32 v208, v208, v120
    v_mul_f32 v209, v209, v120
    v_mul_f32 v210, v210, v120
    v_mul_f32 v211, v211, v120
    v_accvgpr_write_b32 a36, v208
    v_accvgpr_write_b32 a37, v209
    v_accvgpr_write_b32 a38, v210
    v_accvgpr_write_b32 a39, v211
    v_accvgpr_read_b32 v208, a40
    v_accvgpr_read_b32 v209, a41
    v_accvgpr_read_b32 v210, a42
    v_accvgpr_read_b32 v211, a43
    v_mul_f32 v208, v208, v120
    v_mul_f32 v209, v209, v120
    v_mul_f32 v210, v210, v120
    v_mul_f32 v211, v211, v120
    v_accvgpr_write_b32 a40, v208
    v_accvgpr_write_b32 a41, v209
    v_accvgpr_write_b32 a42, v210
    v_accvgpr_write_b32 a43, v211
    v_accvgpr_read_b32 v208, a44
    v_accvgpr_read_b32 v209, a45
    v_accvgpr_read_b32 v210, a46
    v_accvgpr_read_b32 v211, a47
    v_mul_f32 v208, v208, v120
    v_mul_f32 v209, v209, v120
    v_mul_f32 v210, v210, v120
    v_mul_f32 v211, v211, v120
    v_accvgpr_write_b32 a44, v208
    v_accvgpr_write_b32 a45, v209
    v_accvgpr_write_b32 a46, v210
    v_accvgpr_write_b32 a47, v211
    v_accvgpr_read_b32 v208, a48
    v_accvgpr_read_b32 v209, a49
    v_accvgpr_read_b32 v210, a50
    v_accvgpr_read_b32 v211, a51
    v_mul_f32 v208, v208, v120
    v_mul_f32 v209, v209, v120
    v_mul_f32 v210, v210, v120
    v_mul_f32 v211, v211, v120
    v_accvgpr_write_b32 a48, v208
    v_accvgpr_write_b32 a49, v209
    v_accvgpr_write_b32 a50, v210
    v_accvgpr_write_b32 a51, v211
    v_accvgpr_read_b32 v208, a52
    v_accvgpr_read_b32 v209, a53
    v_accvgpr_read_b32 v210, a54
    v_accvgpr_read_b32 v211, a55
    v_mul_f32 v208, v208, v120
    v_mul_f32 v209, v209, v120
    v_mul_f32 v210, v210, v120
    v_mul_f32 v211, v211, v120
    v_accvgpr_write_b32 a52, v208
    v_accvgpr_write_b32 a53, v209
    v_accvgpr_write_b32 a54, v210
    v_accvgpr_write_b32 a55, v211
    v_accvgpr_read_b32 v208, a56
    v_accvgpr_read_b32 v209, a57
    v_accvgpr_read_b32 v210, a58
    v_accvgpr_read_b32 v211, a59
    v_mul_f32 v208, v208, v120
    v_mul_f32 v209, v209, v120
    v_mul_f32 v210, v210, v120
    v_mul_f32 v211, v211, v120
    v_accvgpr_write_b32 a56, v208
    v_accvgpr_write_b32 a57, v209
    v_accvgpr_write_b32 a58, v210
    v_accvgpr_write_b32 a59, v211
    v_accvgpr_read_b32 v208, a60
    v_accvgpr_read_b32 v209, a61
    v_accvgpr_read_b32 v210, a62
    v_accvgpr_read_b32 v211, a63
    v_mul_f32 v208, v208, v120
    v_mul_f32 v209, v209, v120
    v_mul_f32 v210, v210, v120
    v_mul_f32 v211, v211, v120
    v_accvgpr_write_b32 a60, v208
    v_accvgpr_write_b32 a61, v209
    v_accvgpr_write_b32 a62, v210
    v_accvgpr_write_b32 a63, v211
    s_setpc_b64 s[26:27]
.section .rodata,"a"
.p2align 6
.amdhsa_kernel standalone__kv_cache_quant_int4_int2_kv_with_per_channel_or_per_token_scales__sampling_kernel
  .amdhsa_next_free_vgpr 496
  .amdhsa_next_free_sgpr 102
  .amdhsa_accum_offset 256
  .amdhsa_group_segment_fixed_size 0
  .amdhsa_kernarg_size 80
  .amdhsa_user_sgpr_count 2
  .amdhsa_user_sgpr_kernarg_segment_ptr 1
  .amdhsa_system_sgpr_workgroup_id_x 1
  .amdhsa_float_denorm_mode_32 3
.end_amdhsa_kernel
```
